```python
import torch

def _softmax(x, axis=-1):
    return torch.softmax(x, dim=axis)
def _gelu(x):
    return torch.nn.functional.gelu(x, approximate="tanh")
def _silu(x):
    return torch.nn.functional.silu(x)
def _sigmoid(x):
    return torch.sigmoid(x)
def _layernorm(x, axis=-1, eps=1e-5):
    m = x.mean(dim=axis, keepdim=True)
    v = x.var(dim=axis, keepdim=True, unbiased=False)
    return (x - m) / torch.sqrt(v + eps)
def _scatter_add(tgt, idx, src, axis=0):
    return tgt.clone().index_add_(axis, idx, src)
def _segment_sum(src, seg, n):
    out = torch.zeros((n,) + src.shape[1:], dtype=src.dtype)
    return out.index_add_(0, seg, src)
def _pad(x, pw):
    flat = tuple(v for pair in reversed(pw) for v in pair)
    return torch.nn.functional.pad(x, flat)

kernel_name = 'gated_mix__grouped_kv_mqa__moe_arch_mod__prompt'

def setup_inputs():

    _w = (lambda a: (lambda t: t.to(torch.bfloat16) if t.is_floating_point() else t)(torch.as_tensor(a)))
    def _A_setup():
        B, S, D, H = 1, 2048, 640, 32
        Dh = D // H
        return {
            "x": _w((lambda *s: torch.randn(*s, dtype=torch.bfloat16) * 0.05)(B, S, D)),
            "wq": _w((lambda *s: torch.randn(*s, dtype=torch.bfloat16) * 0.8)(D, H * Dh)),
            "wk": _w((lambda *s: torch.randn(*s, dtype=torch.bfloat16) * 0.8)(D, Dh)),
            "wv": _w((lambda *s: torch.randn(*s, dtype=torch.bfloat16) * 0.2)(D, Dh)),
            "wo": _w((lambda *s: torch.randn(*s, dtype=torch.bfloat16) * 0.2)(H * Dh, D)),
        }
    _A_in = _A_setup()

    def _B_setup():
        B, S, D, F, C = 1, 2048, 640, 1536, 1
        return {
            "x": _w((lambda *s: torch.randn(*s, dtype=torch.bfloat16) * 0.05)(B, S, D)),
            "w_r": _w((lambda *s: torch.randn(*s, dtype=torch.bfloat16) * 1.6)(D)),
            "w_gate": _w((lambda *s: torch.randn(*s, dtype=torch.bfloat16) * 0.2)(D, F)),
            "w_up": _w((lambda *s: torch.randn(*s, dtype=torch.bfloat16) * 0.2)(D, F)),
            "w_down": _w((lambda *s: torch.randn(*s, dtype=torch.bfloat16) * 0.2)(F, D)),
        }
    _B_in = _B_setup()

    return {
        "A_x": _A_in["x"],
        "A_wq": _A_in["wq"],
        "A_wk": _A_in["wk"],
        "A_wv": _A_in["wv"],
        "A_wo": _A_in["wo"],
        "B_x": _B_in["x"],
        "B_w_r": _B_in["w_r"],
        "B_w_gate": _B_in["w_gate"],
        "B_w_up": _B_in["w_up"],
        "B_w_down": _B_in["w_down"],
        "gate_w": _w((lambda *s: torch.randn(*s, dtype=torch.bfloat16) * 0.05)(640) * 16.0),
    }

def reference(A_x, A_wq, A_wk, A_wv, A_wo, B_x, B_w_r, B_w_gate, B_w_up, B_w_down, gate_w):
    def _A_ref(x, wq, wk, wv, wo):
        B, S, D = x.shape
        H = 32
        Dh = D // H
        q = (lambda x, *d: x.permute(*d))((x @ wq).reshape(B, S, H, Dh), 0, 2, 1, 3)
        k = x @ wk
        v = x @ wv
        scores = torch.einsum("bhqd,bkd->bhqk", q, k) * (Dh ** -0.5)
        p = _softmax(scores, axis=-1)
        o = torch.einsum("bhqk,bkd->bhqd", p, v)
        return (lambda x, *d: x.permute(*d))(o, 0, 2, 1, 3).reshape(B, S, H * Dh) @ wo

    def _B_ref(x, w_r, w_gate, w_up, w_down):
        B, S, D = x.shape
        C = 1
        r = x @ w_r
        idx = torch.argsort(-r, axis=-1)[:, :C]
        idx_e = (lambda x, n, axis: torch.repeat_interleave(x, n, dim=axis))(idx.reshape(B, C, 1), D, axis=2)
        x_sel = (lambda x, i, axis: torch.take_along_dim(x, i, dim=axis))(x, idx_e, axis=1)
        g = _silu(x_sel @ w_gate)
        u = x_sel @ w_up
        y = (g * u) @ w_down
        r_sel = _sigmoid((lambda x, i, axis: torch.take_along_dim(x, i, dim=axis))(r, idx, axis=1))
        y = y * r_sel.reshape(B, C, 1)
        b_off = (torch.arange(B) * S).reshape(B, 1)
        flat_idx = (idx + b_off).reshape(B * C)
        zero = (x * 0.0).reshape(B * S, D)
        upd = _scatter_add(zero, flat_idx, y.reshape(B * C, D), axis=0)
        return x + upd.reshape(B, S, D)

    x = A_x
    g = _sigmoid((x * gate_w).sum(-1, keepdims=True))
    a = _A_ref(x, A_wq, A_wk, A_wv, A_wo)
    b = _B_ref(x, B_w_r, B_w_gate, B_w_up, B_w_down)
    return g * a + (1 - g) * b
```

```asm
; @launch grid=(256,1,1) block=(512,1,1) lds=163840
.amdgcn_target "amdgcn-amd-amdhsa--gfx950"
.text
.globl gated_mix__grouped_kv_mqa__moe_arch_mod__prompt_kernel
.p2align 8
.type gated_mix__grouped_kv_mqa__moe_arch_mod__prompt_kernel,@function
gated_mix__grouped_kv_mqa__moe_arch_mod__prompt_kernel:
    s_cmp_ge_u32 s2, 256
    s_cbranch_scc1 L_exit_1
    s_load_dwordx4 s[36:39], s[0:1], 0
    s_load_dwordx4 s[40:43], s[0:1], 16
    s_load_dwordx4 s[48:51], s[0:1], 96
    s_load_dwordx2 s[44:45], s[0:1], 48
    s_load_dwordx4 s[4:7], s[0:1], 80
    v_lshrrev_b32 v4, 6, v0
    v_and_b32 v1, 63, v0
    v_readfirstlane_b32 s29, v4
    v_lshlrev_b32 v5, 4, v1
    s_and_b32 s30, s2, 7
    s_lshl_b32 s30, s30, 2
    s_lshr_b32 s28, s2, 6
    s_add_u32 s30, s30, s28
    s_bfe_u32 s31, s2, 0x30003
    s_lshl_b32 s33, s28, 1
    s_sub_u32 s3, s31, s33
    s_and_b32 s3, s3, 7
    s_lshl_b32 s32, s3, 2
    s_lshr_b32 s25, 0x62739540, s32
    s_and_b32 s25, s25, 15
    s_add_u32 s25, s25, s33
    s_cmp_ge_u32 s25, 10
    s_cselect_b32 s32, 10, 0
    s_sub_u32 s25, s25, s32
    s_cmp_lt_u32 s29, 4
    s_cbranch_scc1 L_COMPUTE
L_help_2:
    s_mov_b32 s72, 1
    s_sub_u32 s26, s29, 4
    v_lshrrev_b32 v6, 3, v1
    v_and_b32 v7, 7, v1
    v_lshrrev_b32 v8, 1, v6
    v_xor_b32 v7, v7, v8
    v_mul_u32_u24 v6, 1280, v6
    v_lshl_add_u32 v181, v7, 4, v6
    v_xor_b32 v182, 64, v181
    v_add_u32 v182, 9216, v182
    v_mul_u32_u24 v2, 26, v1
    v_lshrrev_b32 v2, 8, v2
    v_mul_u32_u24 v3, 10, v2
    v_sub_u32 v3, v1, v3
    v_mul_u32_u24 v2, 1280, v2
    v_lshl_add_u32 v172, v3, 4, v2
    v_add_u32 v183, 17920, v172
    s_mul_i32 s63, s30, 81920
    s_mul_i32 s32, s26, 20480
    s_add_u32 s63, s63, s32
    s_lshl_b32 s64, s26, 11
    s_lshr_b32 s32, s26, 1
    s_xor_b32 s32, s32, s26
    s_mul_i32 s61, s32, 5120
    s_mul_i32 s33, s31, 160
    s_add_u32 s61, s61, s33
    s_mul_i32 s62, s26, 640
    s_add_u32 s62, s62, 81920
    s_mov_b32 s66, -1
    s_movk_i32 s67, 0xff
    s_mov_b32 s14, 2621440
    s_mov_b32 s15, 0x00020000
    s_mov_b32 s18, 819200
    s_mov_b32 s19, 0x00020000
    s_mov_b32 s23, 0x00020000
    s_lshl_b32 s35, s26, 10
    s_mov_b32 s65, s25
    s_lshl_b32 s32, s26, 3
    s_or_b32 s32, s32, s3
    s_cmp_lt_u32 s32, 2
    s_cselect_b32 s69, 5, 99
    s_waitcnt lgkmcnt(0)
    s_mov_b32 s12, s36
    s_and_b32 s13, s37, 0xffff
    s_mov_b32 s16, s38
    s_and_b32 s17, s39, 0xffff
    s_cmp_lt_u32 s3, 2
    s_cbranch_scc1 L_prod_75
    s_cmp_lg_u32 s3, 2
    s_cbranch_scc1 L_nv2_77
    s_bitcmp1_b32 s26, 0
    s_cselect_b32 s20, s4, s44
    s_cselect_b32 s21, s5, s45
    s_and_b32 s21, s21, 0xffff
    s_movk_i32 s22, 1280
    s_lshr_b32 s32, s26, 1
    s_mul_i32 s32, s32, 640
    s_and_b32 s33, s26, 1
    s_mul_i32 s33, s33, 1280
    s_add_u32 s33, s33, s32
    s_add_u32 m0, s33, 153600
    s_mov_b64 exec, s[66:67]
    buffer_load_dwordx4 v5, s[20:23], s32 offen lds
    s_mov_b64 exec, -1
L_nv2_77:
L_x_79:
    s_lshl_b32 s32, s65, 7
    s_mov_b32 m0, s64
    s_add_u32 s32, s32, s63
    s_add_u32 s64, s64, 8192
    buffer_load_dwordx4 v181, s[12:15], s32 offen lds
    buffer_load_dwordx4 v182, s[12:15], s32 offen offset:1024 lds
    s_add_u32 s65, s65, 1
    s_cmp_eq_u32 s65, 10
    s_cselect_b32 s65, 0, s65
    s_cmp_lg_u32 s65, s25
    s_cbranch_scc1 L_x_79
    s_mov_b32 s10, 0x1000000
    s_mov_b32 s11, 0x00020000
    s_bfe_u32 s24, s2, 0x40003
    s_mul_i32 s24, s24, 10368
    s_lshl_b32 s73, s28, 1
    s_movk_i32 s78, 256
    s_mov_b32 s79, 0x00020000
    v_and_b32 v2, 15, v0
    v_lshrrev_b32 v3, 4, v1
    s_and_b32 s27, s29, 3
    s_lshr_b32 s28, s29, 2
    v_add_u32 v6, s73, v3
    v_and_b32 v6, 7, v6
    v_lshlrev_b32 v7, 3, v2
    v_lshl_add_u32 v164, v6, 8, v7
    v_xor_b32 v165, 0x400, v164
    v_lshrrev_b32 v7, 2, v2
    v_and_b32 v8, 3, v2
    v_lshrrev_b32 v9, 1, v3
    v_mul_u32_u24 v9, 20, v9
    v_and_b32 v6, 1, v3
    v_lshl_add_u32 v9, v6, 2, v9
    v_add_u32 v9, v9, v7
    v_mul_u32_u24 v9, 160, v9
    v_lshl_add_u32 v9, v8, 3, v9
    s_xor_b32 s32, s28, 1
    s_mul_i32 s32, s32, 51200
    v_add_u32 v160, s32, v9
    v_mul_u32_u24 v9, 40, v3
    v_add3_u32 v9, v9, v7, 16
    v_mul_u32_u24 v9, 160, v9
    v_lshl_add_u32 v9, v8, 3, v9
    v_add_u32 v161, s32, v9
    v_mul_u32_u24 v6, 26, v1
    v_lshrrev_b32 v6, 8, v6
    v_mul_u32_u24 v7, 10, v6
    v_sub_u32 v7, v1, v7
    s_lshl_b32 s32, s30, 6
    s_lshl_b32 s33, s29, 3
    s_add_u32 s52, s32, s33
    v_add_u32 v163, s52, v6
    v_mul_u32_u24 v8, 1280, v163
    v_lshl_add_u32 v8, v7, 4, v8
    s_mul_i32 s54, s31, 160
    v_add_u32 v8, s54, v8
    v_cmp_gt_u32 vcc, 40, v1
    v_mov_b32 v9, 0x40000000
    s_nop 0
    v_cndmask_b32 v162, v9, v8, vcc
    v_add_u32 v6, s33, v6
    v_mul_u32_u24 v6, 336, v6
    v_lshl_add_u32 v6, v7, 5, v6
    v_add_u32 v166, 102400, v6
    v_lshlrev_b32 v7, 5, v7
    v_add_u32 v167, 163456, v7
    s_lshl_b32 s32, s27, 4
    v_add_u32 v6, s32, v2
    v_mul_u32_u24 v6, 336, v6
    v_lshl_add_u32 v6, v3, 4, v6
    s_mul_i32 s32, s28, 21504
    s_add_u32 s32, s32, 102400
    v_add_u32 v168, s32, v6
    s_lshl_b32 s47, s31, 2
    s_add_u32 s47, s47, s27
    v_bfe_u32 v6, v1, 4, 1
    v_mul_u32_u24 v6, 20480, v6
    v_lshrrev_b32 v7, 5, v1
    v_lshl_add_u32 v170, v2, 3, v6
    v_lshl_or_b32 v170, v7, 30, v170
    v_lshl_add_u32 v6, v2, 4, v6
    v_lshl_add_u32 v169, v7, 8, v6
    s_mul_i32 s32, s30, 81920
    s_add_u32 s32, s32, 1048576
    s_lshl_b32 s74, s47, 9
    s_add_u32 s74, s74, s32
    s_lshl_b32 s75, s47, 7
    s_add_u32 s75, s75, s32
    s_add_u32 s75, s75, 16384
    s_add_u32 s58, s74, 40960
    s_add_u32 s59, s75, 40960
    v_mov_b32 v176, -1
    v_mov_b32 v177, -1
    v_mov_b32 v178, -1
    v_mov_b32 v179, -1
    v_mov_b32 v173, 163424
    v_mov_b32 v6, 0
    v_mov_b32 v7, 0
    v_lshlrev_b32 v10, 3, v1
    v_mul_u32_u24 v11, 3072, v1
    v_cmp_gt_u32 vcc, 40, v1
    v_mov_b32 v4, 0x40000000
    s_nop 0
    v_cndmask_b32 v4, v4, v10, vcc
    v_mov_b32 v175, 1
    v_lshlrev_b32 v9, 1, v1
    v_mov_b32 v12, 0
    v_mov_b32 v13, 0
    v_mov_b32 v14, 0
    v_mov_b32 v15, 0
    v_mov_b32 v16, 0
    v_mov_b32 v17, 0
    v_mov_b32 v18, 0
    v_mov_b32 v19, 0
    v_mov_b32 v20, 0
    v_mov_b32 v21, 0
    v_mov_b32 v22, 0
    v_mov_b32 v23, 0
    v_and_b32 v8, 7, v1
    v_lshlrev_b32 v8, 2, v8
    v_add_u32 v8, 163296, v8
    s_lshl_b32 s32, s26, 5
    s_add_u32 s32, s32, 163296
    v_lshl_add_u32 v25, v3, 3, s32
    v_lshlrev_b32 v26, 1, v4
    s_mov_b32 s46, 0
    s_mov_b32 s34, 1
L_l_78:
    s_mul_i32 s33, s25, 81920
    s_mov_b32 m0, s62
    s_add_u32 s33, s33, s61
    s_mov_b64 exec, s[66:67]
    buffer_load_dwordx4 v172, s[16:19], s33 offen lds
    buffer_load_dwordx4 v183, s[16:19], s33 offen offset:2560 lds
    s_add_u32 m0, s62, 5120
    s_add_u32 s33, s33, 40960
    buffer_load_dwordx4 v172, s[16:19], s33 offen lds
    buffer_load_dwordx4 v183, s[16:19], s33 offen offset:2560 lds
    s_mov_b64 exec, -1
    s_add_u32 s62, s62, 10240
    s_cmp_ge_u32 s62, 153600
    s_cselect_b32 s32, 71680, 0
    s_sub_u32 s62, s62, s32
    s_add_u32 s25, s25, 1
    s_cmp_eq_u32 s25, 10
    s_cselect_b32 s25, 0, s25
    s_add_u32 s46, s46, 1
    s_cmp_le_u32 s46, 3
    s_cbranch_scc1 L_l_78
L_lw_81:
    s_cmp_eq_u32 s34, 63
    s_cbranch_scc1 L_chk_82
L_chkr_83:
    s_waitcnt vmcnt(12)
    s_cmp_eq_u32 s34, 63
    s_cbranch_scc1 L_chk_84
L_chkr_85:
    s_barrier
    s_cmp_eq_u32 s34, 63
    s_cbranch_scc1 L_chk_86
L_chkr_87:
    s_cmp_eq_u32 s46, s69
    s_cbranch_scc1 L_sgn_88
L_ns_80:
    s_cmp_lt_u32 s46, 10
    s_cbranch_scc1 L_l_78
    s_waitcnt vmcnt(8)
    s_cmp_eq_u32 s34, 63
    s_cbranch_scc1 L_chk_89
L_chkr_90:
    s_barrier
    s_waitcnt vmcnt(4)
    s_cmp_eq_u32 s34, 63
    s_cbranch_scc1 L_chk_91
L_chkr_92:
    s_barrier
    s_waitcnt vmcnt(0) lgkmcnt(0)
    s_cmp_eq_u32 s34, 63
    s_cbranch_scc1 L_chk_93
L_chkr_94:
    s_barrier
    s_branch L_p1d_76
L_sgn_88:
    s_atomic_add s34, s[48:49], 0x0 glc
    s_branch L_ns_80
L_chk_82:
    s_mov_b32 s34, 1
    s_atomic_add s34, s[48:49], 0x80
    s_branch L_chkr_83
L_chk_84:
    s_mov_b32 s34, 1
    s_atomic_add s34, s[48:49], 0x80
    s_branch L_chkr_85
L_chk_86:
    s_mov_b32 s34, 1
    s_atomic_add s34, s[48:49], 0x80
    s_branch L_chkr_87
L_chk_89:
    s_mov_b32 s34, 1
    s_atomic_add s34, s[48:49], 0x80
    s_branch L_chkr_90
L_chk_91:
    s_mov_b32 s34, 1
    s_atomic_add s34, s[48:49], 0x80
    s_branch L_chkr_92
L_chk_93:
    s_mov_b32 s34, 1
    s_atomic_add s34, s[48:49], 0x80
    s_branch L_chkr_94
L_prod_75:
    s_cmp_eq_u32 s3, 0
    s_cselect_b32 s20, s40, s42
    s_cselect_b32 s21, s41, s43
    s_and_b32 s21, s21, 0xffff
    s_movk_i32 s22, 25600
    s_mul_i32 s35, s26, 640
    s_add_u32 s68, s35, 133120
    s_mov_b32 s46, 0
L_a_95:
    s_mul_i32 s34, s65, 2560
    s_mov_b32 m0, s68
    s_add_u32 s34, s34, s35
    s_mov_b64 exec, s[66:67]
    buffer_load_dwordx4 v5, s[20:23], s34 offen lds
    buffer_load_dwordx4 v5, s[20:23], s34 offen offset:2560 lds
    s_mov_b64 exec, -1
    s_add_u32 s68, s68, 5120
    s_lshl_b32 s32, s65, 7
    s_mov_b32 m0, s64
    s_add_u32 s32, s32, s63
    s_add_u32 s64, s64, 8192
    buffer_load_dwordx4 v181, s[12:15], s32 offen lds
    buffer_load_dwordx4 v182, s[12:15], s32 offen offset:1024 lds
    s_add_u32 s65, s65, 1
    s_cmp_eq_u32 s65, 10
    s_cselect_b32 s65, 0, s65
    s_lshl_b32 s32, s65, 7
    s_mov_b32 m0, s64
    s_add_u32 s32, s32, s63
    s_add_u32 s64, s64, 8192
    buffer_load_dwordx4 v181, s[12:15], s32 offen lds
    buffer_load_dwordx4 v182, s[12:15], s32 offen offset:1024 lds
    s_add_u32 s65, s65, 1
    s_cmp_eq_u32 s65, 10
    s_cselect_b32 s65, 0, s65
    s_add_u32 s46, s46, 1
    s_cmp_le_u32 s46, 2
    s_cbranch_scc1 L_a_95
    s_waitcnt vmcnt(12)
    s_barrier
    s_cmp_lt_u32 s46, 5
    s_cbranch_scc1 L_a_95
    s_mov_b32 s46, 0
    s_mul_i32 s33, s25, 81920
    s_mov_b32 m0, s62
    s_add_u32 s33, s33, s61
    s_mov_b64 exec, s[66:67]
    buffer_load_dwordx4 v172, s[16:19], s33 offen lds
    buffer_load_dwordx4 v183, s[16:19], s33 offen offset:2560 lds
    s_add_u32 m0, s62, 5120
    s_add_u32 s33, s33, 40960
    buffer_load_dwordx4 v172, s[16:19], s33 offen lds
    buffer_load_dwordx4 v183, s[16:19], s33 offen offset:2560 lds
    s_mov_b64 exec, -1
    s_add_u32 s62, s62, 10240
    s_cmp_ge_u32 s62, 153600
    s_cselect_b32 s32, 71680, 0
    s_sub_u32 s62, s62, s32
    s_add_u32 s25, s25, 1
    s_cmp_eq_u32 s25, 10
    s_cselect_b32 s25, 0, s25
    s_waitcnt vmcnt(10)
    s_barrier
    s_mul_i32 s33, s25, 81920
    s_mov_b32 m0, s62
    s_add_u32 s33, s33, s61
    s_mov_b64 exec, s[66:67]
    buffer_load_dwordx4 v172, s[16:19], s33 offen lds
    buffer_load_dwordx4 v183, s[16:19], s33 offen offset:2560 lds
    s_add_u32 m0, s62, 5120
    s_add_u32 s33, s33, 40960
    buffer_load_dwordx4 v172, s[16:19], s33 offen lds
    buffer_load_dwordx4 v183, s[16:19], s33 offen offset:2560 lds
    s_mov_b64 exec, -1
    s_add_u32 s62, s62, 10240
    s_cmp_ge_u32 s62, 153600
    s_cselect_b32 s32, 71680, 0
    s_sub_u32 s62, s62, s32
    s_add_u32 s25, s25, 1
    s_cmp_eq_u32 s25, 10
    s_cselect_b32 s25, 0, s25
    s_waitcnt vmcnt(8)
    s_barrier
    s_mul_i32 s33, s25, 81920
    s_mov_b32 m0, s62
    s_add_u32 s33, s33, s61
    s_mov_b64 exec, s[66:67]
    buffer_load_dwordx4 v172, s[16:19], s33 offen lds
    buffer_load_dwordx4 v183, s[16:19], s33 offen offset:2560 lds
    s_add_u32 m0, s62, 5120
    s_add_u32 s33, s33, 40960
    buffer_load_dwordx4 v172, s[16:19], s33 offen lds
    buffer_load_dwordx4 v183, s[16:19], s33 offen offset:2560 lds
    s_mov_b64 exec, -1
    s_add_u32 s62, s62, 10240
    s_cmp_ge_u32 s62, 153600
    s_cselect_b32 s32, 71680, 0
    s_sub_u32 s62, s62, s32
    s_add_u32 s25, s25, 1
    s_cmp_eq_u32 s25, 10
    s_cselect_b32 s25, 0, s25
    s_barrier
    s_mul_i32 s33, s25, 81920
    s_mov_b32 m0, s62
    s_add_u32 s33, s33, s61
    s_mov_b64 exec, s[66:67]
    buffer_load_dwordx4 v172, s[16:19], s33 offen lds
    buffer_load_dwordx4 v183, s[16:19], s33 offen offset:2560 lds
    s_add_u32 m0, s62, 5120
    s_add_u32 s33, s33, 40960
    buffer_load_dwordx4 v172, s[16:19], s33 offen lds
    buffer_load_dwordx4 v183, s[16:19], s33 offen offset:2560 lds
    s_mov_b64 exec, -1
    s_add_u32 s62, s62, 10240
    s_cmp_ge_u32 s62, 153600
    s_cselect_b32 s32, 71680, 0
    s_sub_u32 s62, s62, s32
    s_add_u32 s25, s25, 1
    s_cmp_eq_u32 s25, 10
    s_cselect_b32 s25, 0, s25
    s_mov_b32 s10, 0x1000000
    s_mov_b32 s11, 0x00020000
    s_bfe_u32 s24, s2, 0x40003
    s_mul_i32 s24, s24, 10368
    s_lshl_b32 s73, s28, 1
    s_movk_i32 s78, 256
    s_mov_b32 s79, 0x00020000
    v_and_b32 v2, 15, v0
    v_lshrrev_b32 v3, 4, v1
    s_and_b32 s27, s29, 3
    s_lshr_b32 s28, s29, 2
    v_add_u32 v6, s73, v3
    v_and_b32 v6, 7, v6
    v_lshlrev_b32 v7, 3, v2
    v_lshl_add_u32 v164, v6, 8, v7
    v_xor_b32 v165, 0x400, v164
    v_lshrrev_b32 v7, 2, v2
    v_and_b32 v8, 3, v2
    v_lshrrev_b32 v9, 1, v3
    v_mul_u32_u24 v9, 20, v9
    v_and_b32 v6, 1, v3
    v_lshl_add_u32 v9, v6, 2, v9
    v_add_u32 v9, v9, v7
    v_mul_u32_u24 v9, 160, v9
    v_lshl_add_u32 v9, v8, 3, v9
    s_xor_b32 s32, s28, 1
    s_mul_i32 s32, s32, 51200
    v_add_u32 v160, s32, v9
    v_mul_u32_u24 v9, 40, v3
    v_add3_u32 v9, v9, v7, 16
    v_mul_u32_u24 v9, 160, v9
    v_lshl_add_u32 v9, v8, 3, v9
    v_add_u32 v161, s32, v9
    v_mul_u32_u24 v6, 26, v1
    v_lshrrev_b32 v6, 8, v6
    v_mul_u32_u24 v7, 10, v6
    v_sub_u32 v7, v1, v7
    s_lshl_b32 s32, s30, 6
    s_lshl_b32 s33, s29, 3
    s_add_u32 s52, s32, s33
    v_add_u32 v163, s52, v6
    v_mul_u32_u24 v8, 1280, v163
    v_lshl_add_u32 v8, v7, 4, v8
    s_mul_i32 s54, s31, 160
    v_add_u32 v8, s54, v8
    v_cmp_gt_u32 vcc, 40, v1
    v_mov_b32 v9, 0x40000000
    s_nop 0
    v_cndmask_b32 v162, v9, v8, vcc
    v_add_u32 v6, s33, v6
    v_mul_u32_u24 v6, 336, v6
    v_lshl_add_u32 v6, v7, 5, v6
    v_add_u32 v166, 102400, v6
    v_lshlrev_b32 v7, 5, v7
    v_add_u32 v167, 163456, v7
    s_lshl_b32 s32, s27, 4
    v_add_u32 v6, s32, v2
    v_mul_u32_u24 v6, 336, v6
    v_lshl_add_u32 v6, v3, 4, v6
    s_mul_i32 s32, s28, 21504
    s_add_u32 s32, s32, 102400
    v_add_u32 v168, s32, v6
    s_lshl_b32 s47, s31, 2
    s_add_u32 s47, s47, s27
    v_bfe_u32 v6, v1, 4, 1
    v_mul_u32_u24 v6, 20480, v6
    v_lshrrev_b32 v7, 5, v1
    v_lshl_add_u32 v170, v2, 3, v6
    v_lshl_or_b32 v170, v7, 30, v170
    v_lshl_add_u32 v6, v2, 4, v6
    v_lshl_add_u32 v169, v7, 8, v6
    s_mul_i32 s32, s30, 81920
    s_add_u32 s32, s32, 1048576
    s_lshl_b32 s74, s47, 9
    s_add_u32 s74, s74, s32
    s_lshl_b32 s75, s47, 7
    s_add_u32 s75, s75, s32
    s_add_u32 s75, s75, 16384
    s_add_u32 s58, s74, 40960
    s_add_u32 s59, s75, 40960
    v_mov_b32 v176, -1
    v_mov_b32 v177, -1
    v_mov_b32 v178, -1
    v_mov_b32 v179, -1
    v_mov_b32 v173, 163424
    v_mov_b32 v6, 0
    v_mov_b32 v7, 0
    v_lshlrev_b32 v10, 3, v1
    v_mul_u32_u24 v11, 3072, v1
    v_cmp_gt_u32 vcc, 40, v1
    v_mov_b32 v4, 0x40000000
    s_nop 0
    v_cndmask_b32 v4, v4, v10, vcc
    v_mov_b32 v175, 1
    v_lshlrev_b32 v9, 1, v1
    v_mov_b32 v12, 0
    v_mov_b32 v13, 0
    v_mov_b32 v14, 0
    v_mov_b32 v15, 0
    v_mov_b32 v16, 0
    v_mov_b32 v17, 0
    v_mov_b32 v18, 0
    v_mov_b32 v19, 0
    v_mov_b32 v20, 0
    v_mov_b32 v21, 0
    v_mov_b32 v22, 0
    v_mov_b32 v23, 0
    v_and_b32 v8, 7, v1
    v_lshlrev_b32 v8, 2, v8
    v_add_u32 v8, 163296, v8
    s_lshl_b32 s32, s26, 5
    s_add_u32 s32, s32, 163296
    v_lshl_add_u32 v25, v3, 3, s32
    v_lshlrev_b32 v26, 1, v4
    s_mov_b32 s46, 4
    s_mov_b32 s34, 1
    s_branch L_lw_81
L_p1d_76:
    s_branch L_HELP2
L_COMPUTE:
    s_mov_b32 s72, 0
    s_getpc_b64 s[32:33]
L_PC0:
    s_sub_u32 s32, s32, L_PC0-gated_mix__grouped_kv_mqa__moe_arch_mod__prompt_kernel
    s_subb_u32 s33, s33, 0
    s_lshr_b32 s34, s2, 3
    v_lshl_add_u32 v6, v0, 5, s34
    v_lshlrev_b32 v6, 7, v6
    v_min_u32 v6, L_CODE_END-gated_mix__grouped_kv_mqa__moe_arch_mod__prompt_kernel-4, v6
    global_load_dword v180, v6, s[32:33]
    s_mov_b32 s10, 0x1000000
    s_mov_b32 s11, 0x00020000
    s_bfe_u32 s24, s2, 0x40003
    s_mul_i32 s24, s24, 10368
    s_lshl_b32 s73, s28, 1
    s_movk_i32 s78, 256
    s_mov_b32 s79, 0x00020000
    v_and_b32 v2, 15, v0
    v_lshrrev_b32 v3, 4, v1
    s_and_b32 s27, s29, 3
    s_lshr_b32 s28, s29, 2
    v_add_u32 v6, s73, v3
    v_and_b32 v6, 7, v6
    v_lshlrev_b32 v7, 3, v2
    v_lshl_add_u32 v164, v6, 8, v7
    v_xor_b32 v165, 0x400, v164
    v_lshrrev_b32 v7, 2, v2
    v_and_b32 v8, 3, v2
    v_lshrrev_b32 v9, 1, v3
    v_mul_u32_u24 v9, 20, v9
    v_and_b32 v6, 1, v3
    v_lshl_add_u32 v9, v6, 2, v9
    v_add_u32 v9, v9, v7
    v_mul_u32_u24 v9, 160, v9
    v_lshl_add_u32 v9, v8, 3, v9
    s_xor_b32 s32, s28, 1
    s_mul_i32 s32, s32, 51200
    v_add_u32 v160, s32, v9
    v_mul_u32_u24 v9, 40, v3
    v_add3_u32 v9, v9, v7, 16
    v_mul_u32_u24 v9, 160, v9
    v_lshl_add_u32 v9, v8, 3, v9
    v_add_u32 v161, s32, v9
    v_mul_u32_u24 v6, 26, v1
    v_lshrrev_b32 v6, 8, v6
    v_mul_u32_u24 v7, 10, v6
    v_sub_u32 v7, v1, v7
    s_lshl_b32 s32, s30, 6
    s_lshl_b32 s33, s29, 3
    s_add_u32 s52, s32, s33
    v_add_u32 v163, s52, v6
    v_mul_u32_u24 v8, 1280, v163
    v_lshl_add_u32 v8, v7, 4, v8
    s_mul_i32 s54, s31, 160
    v_add_u32 v8, s54, v8
    v_cmp_gt_u32 vcc, 40, v1
    v_mov_b32 v9, 0x40000000
    s_nop 0
    v_cndmask_b32 v162, v9, v8, vcc
    v_add_u32 v6, s33, v6
    v_mul_u32_u24 v6, 336, v6
    v_lshl_add_u32 v6, v7, 5, v6
    v_add_u32 v166, 102400, v6
    v_lshlrev_b32 v7, 5, v7
    v_add_u32 v167, 163456, v7
    s_lshl_b32 s32, s27, 4
    v_add_u32 v6, s32, v2
    v_mul_u32_u24 v6, 336, v6
    v_lshl_add_u32 v6, v3, 4, v6
    s_mul_i32 s32, s28, 21504
    s_add_u32 s32, s32, 102400
    v_add_u32 v168, s32, v6
    s_lshl_b32 s33, s30, 2
    s_add_u32 s33, s33, s27
    s_mul_i32 s68, s33, 20480
    s_add_u32 s68, s68, 1048576
    s_lshl_b32 s33, s28, 11
    s_add_u32 s70, s68, s33
    s_add_u32 s70, s70, 16384
    s_lshl_b32 s33, s28, 13
    s_add_u32 s68, s68, s33
    s_add_u32 s32, s73, 0
    s_and_b32 s32, s32, 7
    s_lshl_b32 s12, s32, 10
    s_add_u32 s12, s12, s68
    s_add_u32 s32, s73, 1
    s_and_b32 s32, s32, 7
    s_lshl_b32 s13, s32, 10
    s_add_u32 s13, s13, s68
    s_add_u32 s32, s73, 2
    s_and_b32 s32, s32, 7
    s_lshl_b32 s14, s32, 10
    s_add_u32 s14, s14, s68
    s_add_u32 s32, s73, 3
    s_and_b32 s32, s32, 7
    s_lshl_b32 s15, s32, 10
    s_add_u32 s15, s15, s68
    s_add_u32 s32, s73, 4
    s_and_b32 s32, s32, 7
    s_lshl_b32 s16, s32, 10
    s_add_u32 s16, s16, s68
    s_add_u32 s32, s73, 5
    s_and_b32 s32, s32, 7
    s_lshl_b32 s17, s32, 10
    s_add_u32 s17, s17, s68
    s_add_u32 s32, s73, 6
    s_and_b32 s32, s32, 7
    s_lshl_b32 s18, s32, 10
    s_add_u32 s18, s18, s68
    s_add_u32 s32, s73, 7
    s_and_b32 s32, s32, 7
    s_lshl_b32 s19, s32, 10
    s_add_u32 s19, s19, s68
    s_movk_i32 s55, 5120
    s_mov_b32 s22, 2621440
    s_mov_b32 s23, 0x00020000
    v_lshrrev_b32 v6, 2, v2
    v_and_b32 v7, 3, v2
    v_lshl_add_u32 v6, v3, 3, v6
    v_and_b32 v8, 1, v3
    v_lshlrev_b32 v8, 2, v8
    v_add_u32 v9, v6, v8
    v_mul_u32_u24 v9, 160, v9
    v_lshl_add_u32 v9, v7, 3, v9
    v_add_u32 v14, 81920, v9
    v_xor_b32 v8, 4, v8
    v_add_u32 v9, v6, v8
    v_mul_u32_u24 v9, 160, v9
    v_lshl_add_u32 v9, v7, 3, v9
    v_add_u32 v15, 81920, v9
    v_mul_u32_u24 v9, 40, v6
    v_add_u32 v9, 133120, v9
    v_lshl_add_u32 v18, v7, 3, v9
    v_add_u32 v19, 32, v9
    v_lshrrev_b32 v6, 1, v2
    v_xor_b32 v6, v6, v3
    v_lshlrev_b32 v6, 4, v6
    v_lshl_add_u32 v6, v2, 7, v6
    s_lshl_b32 s32, s29, 11
    v_add_u32 v10, s32, v6
    v_xor_b32 v11, 64, v10
    v_mov_b32 v16, v10
    v_mov_b32 v17, v11
    v_mov_b32 v32, 0
    v_mov_b32 v33, 0
    v_mov_b32 v34, 0
    v_mov_b32 v35, 0
    v_mov_b32 v36, 0
    v_mov_b32 v37, 0
    v_mov_b32 v38, 0
    v_mov_b32 v39, 0
    v_mov_b32 v40, 0
    v_mov_b32 v41, 0
    v_mov_b32 v42, 0
    v_mov_b32 v43, 0
    v_mov_b32 v44, 0
    v_mov_b32 v45, 0
    v_mov_b32 v46, 0
    v_mov_b32 v47, 0
    v_mov_b32 v48, 0
    v_mov_b32 v49, 0
    v_mov_b32 v50, 0
    v_mov_b32 v51, 0
    v_mov_b32 v52, 0
    v_mov_b32 v53, 0
    v_mov_b32 v54, 0
    v_mov_b32 v55, 0
    v_mov_b32 v56, 0
    v_mov_b32 v57, 0
    v_mov_b32 v58, 0
    v_mov_b32 v59, 0
    s_lshr_b32 s32, s29, 1
    s_mul_i32 s32, s32, 5120
    s_and_b32 s33, s29, 1
    s_lshl_b32 s33, s33, 7
    s_add_u32 s32, s32, s33
    s_add_u32 s32, s32, 153600
    v_lshlrev_b32 v6, 3, v2
    v_lshl_add_u32 v6, v3, 8, v6
    v_add_u32 v13, s32, v6
    s_lshl_b32 s47, s31, 2
    s_add_u32 s47, s47, s27
    v_bfe_u32 v6, v1, 4, 1
    v_mul_u32_u24 v6, 20480, v6
    v_lshrrev_b32 v7, 5, v1
    v_lshl_add_u32 v170, v2, 3, v6
    v_lshl_or_b32 v170, v7, 30, v170
    v_lshl_add_u32 v6, v2, 4, v6
    v_lshl_add_u32 v169, v7, 8, v6
    s_mul_i32 s32, s30, 81920
    s_add_u32 s32, s32, 1048576
    s_lshl_b32 s74, s47, 9
    s_add_u32 s74, s74, s32
    s_lshl_b32 s75, s47, 7
    s_add_u32 s75, s75, s32
    s_add_u32 s75, s75, 16384
    s_add_u32 s58, s74, 40960
    s_add_u32 s59, s75, 40960
    s_waitcnt lgkmcnt(0)
    s_mov_b32 s8, s50
    s_and_b32 s9, s51, 0xffff
    s_mov_b32 s76, s48
    s_and_b32 s77, s49, 0xffff
    s_mov_b32 s4, s36
    s_mov_b32 s5, s37
    v_lshlrev_b32 v24, 24, v1
    s_lshl_b32 s32, s30, 6
    s_lshl_b32 s33, s29, 4
    s_add_u32 s50, s32, s33
    s_cmp_gt_u32 s3, 2
    s_cbranch_scc1 L_main_4
    s_cmp_eq_u32 s3, 2
    s_cbranch_scc1 L_rg_5
    s_mov_b32 s46, 0
    s_barrier
    ds_read_b128 v[112:115], v10 offset:0
    ds_read_b64_tr_b16 v[64:65], v18 offset:0
    ds_read_b64_tr_b16 v[66:67], v18 offset:160
    ds_read_b64_tr_b16 v[68:69], v19 offset:0
    ds_read_b64_tr_b16 v[70:71], v19 offset:160
    ds_read_b128 v[116:119], v11 offset:0
    ds_read_b64_tr_b16 v[72:73], v18 offset:1280
    ds_read_b64_tr_b16 v[74:75], v18 offset:1440
    ds_read_b64_tr_b16 v[76:77], v19 offset:1280
    ds_read_b64_tr_b16 v[78:79], v19 offset:1440
    s_cmp_eq_u32 s3, 1
    s_cbranch_scc1 L_ev_6
L_el_8:
    ds_read_b128 v[120:123], v10 offset:8192
    ds_read_b64_tr_b16 v[80:81], v18 offset:2560
    ds_read_b64_tr_b16 v[82:83], v18 offset:2720
    ds_read_b64_tr_b16 v[84:85], v19 offset:2560
    ds_read_b64_tr_b16 v[86:87], v19 offset:2720
    s_waitcnt lgkmcnt(10)
    v_mfma_f32_16x16x32_bf16 v[52:55], v[64:67], v[112:115], v[52:55]
    v_mfma_f32_16x16x32_bf16 v[56:59], v[68:71], v[112:115], v[56:59]
    ds_read_b128 v[124:127], v11 offset:8192
    ds_read_b64_tr_b16 v[88:89], v18 offset:3840
    ds_read_b64_tr_b16 v[90:91], v18 offset:4000
    ds_read_b64_tr_b16 v[92:93], v19 offset:3840
    ds_read_b64_tr_b16 v[94:95], v19 offset:4000
    s_waitcnt lgkmcnt(10)
    v_mfma_f32_16x16x32_bf16 v[52:55], v[72:75], v[116:119], v[52:55]
    v_mfma_f32_16x16x32_bf16 v[56:59], v[76:79], v[116:119], v[56:59]
    s_add_u32 s46, s46, 1
    v_add_u32 v10, 16384, v10
    v_add_u32 v11, 16384, v11
    v_add_u32 v18, 5120, v18
    v_add_u32 v19, 5120, v19
    s_cmp_lt_u32 s46, 5
    s_barrier
    ds_read_b128 v[112:115], v10 offset:0
    ds_read_b64_tr_b16 v[64:65], v18 offset:0
    ds_read_b64_tr_b16 v[66:67], v18 offset:160
    ds_read_b64_tr_b16 v[68:69], v19 offset:0
    ds_read_b64_tr_b16 v[70:71], v19 offset:160
    s_waitcnt lgkmcnt(10)
    v_mfma_f32_16x16x32_bf16 v[52:55], v[80:83], v[120:123], v[52:55]
    v_mfma_f32_16x16x32_bf16 v[56:59], v[84:87], v[120:123], v[56:59]
    ds_read_b128 v[116:119], v11 offset:0
    ds_read_b64_tr_b16 v[72:73], v18 offset:1280
    ds_read_b64_tr_b16 v[74:75], v18 offset:1440
    ds_read_b64_tr_b16 v[76:77], v19 offset:1280
    ds_read_b64_tr_b16 v[78:79], v19 offset:1440
    s_waitcnt lgkmcnt(10)
    v_mfma_f32_16x16x32_bf16 v[52:55], v[88:91], v[124:127], v[52:55]
    v_mfma_f32_16x16x32_bf16 v[56:59], v[92:95], v[124:127], v[56:59]
    s_cbranch_scc1 L_el_8
    s_branch L_ej_7
L_ev_6:
L_el_9:
    ds_read_b128 v[120:123], v10 offset:8192
    ds_read_b64_tr_b16 v[80:81], v18 offset:2560
    ds_read_b64_tr_b16 v[82:83], v18 offset:2720
    ds_read_b64_tr_b16 v[84:85], v19 offset:2560
    ds_read_b64_tr_b16 v[86:87], v19 offset:2720
    s_waitcnt lgkmcnt(10)
    v_mfma_f32_16x16x32_bf16 v[52:55], v[112:115], v[64:67], v[52:55]
    v_mfma_f32_16x16x32_bf16 v[56:59], v[112:115], v[68:71], v[56:59]
    ds_read_b128 v[124:127], v11 offset:8192
    ds_read_b64_tr_b16 v[88:89], v18 offset:3840
    ds_read_b64_tr_b16 v[90:91], v18 offset:4000
    ds_read_b64_tr_b16 v[92:93], v19 offset:3840
    ds_read_b64_tr_b16 v[94:95], v19 offset:4000
    s_waitcnt lgkmcnt(10)
    v_mfma_f32_16x16x32_bf16 v[52:55], v[116:119], v[72:75], v[52:55]
    v_mfma_f32_16x16x32_bf16 v[56:59], v[116:119], v[76:79], v[56:59]
    s_add_u32 s46, s46, 1
    v_add_u32 v10, 16384, v10
    v_add_u32 v11, 16384, v11
    v_add_u32 v18, 5120, v18
    v_add_u32 v19, 5120, v19
    s_cmp_lt_u32 s46, 5
    s_barrier
    ds_read_b128 v[112:115], v10 offset:0
    ds_read_b64_tr_b16 v[64:65], v18 offset:0
    ds_read_b64_tr_b16 v[66:67], v18 offset:160
    ds_read_b64_tr_b16 v[68:69], v19 offset:0
    ds_read_b64_tr_b16 v[70:71], v19 offset:160
    s_waitcnt lgkmcnt(10)
    v_mfma_f32_16x16x32_bf16 v[52:55], v[120:123], v[80:83], v[52:55]
    v_mfma_f32_16x16x32_bf16 v[56:59], v[120:123], v[84:87], v[56:59]
    ds_read_b128 v[116:119], v11 offset:0
    ds_read_b64_tr_b16 v[72:73], v18 offset:1280
    ds_read_b64_tr_b16 v[74:75], v18 offset:1440
    ds_read_b64_tr_b16 v[76:77], v19 offset:1280
    ds_read_b64_tr_b16 v[78:79], v19 offset:1440
    s_waitcnt lgkmcnt(10)
    v_mfma_f32_16x16x32_bf16 v[52:55], v[124:127], v[88:91], v[52:55]
    v_mfma_f32_16x16x32_bf16 v[56:59], v[124:127], v[92:95], v[56:59]
    s_cbranch_scc1 L_el_9
L_ej_7:
    s_lshl_b32 s32, s30, 1
    s_lshr_b32 s33, s29, 1
    s_add_u32 s51, s32, s33
    s_and_b32 s53, s29, 1
    v_lshrrev_b32 v6, 1, v3
    v_and_b32 v7, 1, v3
    s_nop 1
    v_cvt_pk_bf16_f32 v52, v52, v53
    v_cvt_pk_bf16_f32 v53, v54, v55
    v_cvt_pk_bf16_f32 v56, v56, v57
    v_cvt_pk_bf16_f32 v57, v58, v59
    s_cmp_eq_u32 s3, 1
    s_cbranch_scc1 L_sv_10
    s_mov_b32 s60, 165888
    s_add_u32 s51, s51, 62
    s_and_b32 s51, s51, 63
    s_cselect_b32 s34, 0x40000000, s60
    s_mul_i32 s51, s51, 2592
    s_lshl_b32 s33, s53, 4
    v_add_u32 v8, s33, v2
    v_lshl_add_u32 v6, v6, 5, v8
    v_lshlrev_b32 v6, 4, v6
    v_lshl_add_u32 v6, v7, 3, v6
    buffer_store_dwordx2 v[52:53], v6, s[8:11], s51 offen sc1
    buffer_store_dwordx2 v[52:53], v6, s[8:11], s34 offen sc1
    v_cmp_eq_u32 vcc, 0, v3
    v_lshlrev_b32 v6, 3, v8
    v_lshl_or_b32 v6, v3, 28, v6
    buffer_store_dwordx2 v[56:57], v6, s[8:11], s51 offen offset:1024 sc1
    v_cndmask_b32 v8, 0, v56, vcc
    v_cndmask_b32 v9, 0, v57, vcc
    v_mov_b32 v7, 0
    v_dot2c_f32_bf16 v7, v52, v52
    v_dot2c_f32_bf16 v7, v53, v53
    v_dot2c_f32_bf16 v7, v8, v8
    v_dot2c_f32_bf16 v7, v9, v9
    s_nop 2
    v_mov_b32 v6, v7
    s_nop 1
    v_permlane32_swap_b32 v6, v7
    s_nop 1
    v_add_f32 v7, v6, v7
    v_mov_b32 v6, v7
    s_nop 1
    v_permlane16_swap_b32 v6, v7
    s_nop 1
    v_add_f32 v7, v6, v7
    s_mov_b32 s34, 393216
    s_branch L_fin_11
L_sv_10:
    s_add_u32 s51, s51, 63
    s_and_b32 s51, s51, 63
    s_mul_i32 s51, s51, 2592
    s_mul_i32 s33, s53, 656
    s_add_u32 s51, s51, s33
    v_mul_u32_u24 v6, 20, v6
    v_add_u32 v6, v6, v2
    v_lshlrev_b32 v6, 4, v6
    v_lshl_add_u32 v6, v7, 3, v6
    buffer_store_dwordx2 v[52:53], v6, s[8:11], s51 offen offset:1280 sc1
    v_cmp_eq_u32 vcc, 4, v2
    v_mov_b32 v8, 0x3f803f80
    s_nop 0
    v_cndmask_b32 v56, v56, v8, vcc
    v_cndmask_b32 v57, v57, v8, vcc
    v_lshrrev_b32 v8, 1, v3
    v_add_u32 v8, 4, v8
    v_cmp_gt_u32 vcc, v8, v2
    v_mov_b32 v8, 0x40000000
    s_nop 0
    v_cndmask_b32 v6, v8, v6, vcc
    buffer_store_dwordx2 v[56:57], v6, s[8:11], s51 offen offset:1536 sc1
    s_branch L_main_4
L_rg_5:
    v_and_b32 v6, 1, v2
    v_mul_u32_u24 v6, 1280, v6
    v_lshl_add_u32 v18, v3, 4, v6
    v_add_u32 v18, 153600, v18
    s_branch L_main_4
L_fin_11:
    s_nop 1
    v_max_u32_dpp v7, v7, v7 row_ror:8 row_mask:0xf bank_mask:0xf
    s_nop 1
    v_max_u32_dpp v7, v7, v7 row_ror:4 row_mask:0xf bank_mask:0xf
    s_nop 1
    v_max_u32_dpp v7, v7, v7 row_ror:2 row_mask:0xf bank_mask:0xf
    s_nop 1
    v_max_u32_dpp v7, v7, v7 row_ror:1 row_mask:0xf bank_mask:0xf
    s_lshr_b32 s33, s50, 2
    s_add_u32 s33, s33, s34
    v_lshlrev_b32 v6, 24, v1
    buffer_store_dword v7, v6, s[8:11], s33 offen sc1
L_main_4:
    s_mov_b32 s46, 0
    s_mov_b32 s34, -61440
    s_lshl_b32 s32, s25, 7
    v_add_u32 v6, s32, v18
    s_waitcnt lgkmcnt(0)
    s_barrier
    ds_read_b128 v[112:115], v6
    ds_read_b128 v[116:119], v6 offset:64
    ds_read_b128 v[104:107], v16
    ds_read_b64_tr_b16 v[64:65], v14 offset:0
    ds_read_b64_tr_b16 v[66:67], v15 offset:0
    ds_read_b64_tr_b16 v[68:69], v14 offset:32
    ds_read_b64_tr_b16 v[70:71], v15 offset:32
    ds_read_b64_tr_b16 v[72:73], v14 offset:64
    ds_read_b64_tr_b16 v[74:75], v15 offset:64
    ds_read_b64_tr_b16 v[76:77], v14 offset:96
    ds_read_b64_tr_b16 v[78:79], v15 offset:96
    ds_read_b64_tr_b16 v[80:81], v14 offset:128
    ds_read_b64_tr_b16 v[82:83], v15 offset:128
    s_cmp_eq_u32 s3, 2
    s_cbranch_scc1 L_rgl_15
L_c_17:
    s_add_u32 s46, s46, 1
    s_cmp_eq_u32 s46, 7
    s_cselect_b32 s32, s34, 10240
    ds_read_b128 v[108:111], v17
    ds_read_b64_tr_b16 v[84:85], v14 offset:5120
    ds_read_b64_tr_b16 v[86:87], v15 offset:5120
    s_waitcnt lgkmcnt(11)
    v_mfma_f32_16x16x32_bf16 v[32:35], v[64:67], v[104:107], v[32:35]
    ds_read_b64_tr_b16 v[88:89], v14 offset:5152
    ds_read_b64_tr_b16 v[90:91], v15 offset:5152
    s_waitcnt lgkmcnt(11)
    v_mfma_f32_16x16x32_bf16 v[36:39], v[68:71], v[104:107], v[36:39]
    ds_read_b64_tr_b16 v[92:93], v14 offset:5184
    ds_read_b64_tr_b16 v[94:95], v15 offset:5184
    s_waitcnt lgkmcnt(11)
    v_mfma_f32_16x16x32_bf16 v[40:43], v[72:75], v[104:107], v[40:43]
    ds_read_b64_tr_b16 v[96:97], v14 offset:5216
    ds_read_b64_tr_b16 v[98:99], v15 offset:5216
    s_waitcnt lgkmcnt(11)
    v_mfma_f32_16x16x32_bf16 v[44:47], v[76:79], v[104:107], v[44:47]
    ds_read_b64_tr_b16 v[100:101], v14 offset:5248
    ds_read_b64_tr_b16 v[102:103], v15 offset:5248
    s_waitcnt lgkmcnt(11)
    v_mfma_f32_16x16x32_bf16 v[48:51], v[80:83], v[104:107], v[48:51]
    v_add_u32 v14, s32, v14
    v_add_u32 v15, s32, v15
    v_add_u32 v16, 8192, v16
    v_add_u32 v17, 8192, v17
    s_cmp_eq_u32 s46, 1
    s_cbranch_scc1 L_aw_13
L_awr_14:
    s_cmp_lt_u32 s46, 10
    s_barrier
    ds_read_b128 v[104:107], v16
    ds_read_b64_tr_b16 v[64:65], v14 offset:0
    ds_read_b64_tr_b16 v[66:67], v15 offset:0
    s_waitcnt lgkmcnt(11)
    v_mfma_f32_16x16x32_bf16 v[32:35], v[84:87], v[108:111], v[32:35]
    ds_read_b64_tr_b16 v[68:69], v14 offset:32
    ds_read_b64_tr_b16 v[70:71], v15 offset:32
    s_waitcnt lgkmcnt(11)
    v_mfma_f32_16x16x32_bf16 v[36:39], v[88:91], v[108:111], v[36:39]
    ds_read_b64_tr_b16 v[72:73], v14 offset:64
    ds_read_b64_tr_b16 v[74:75], v15 offset:64
    s_waitcnt lgkmcnt(11)
    v_mfma_f32_16x16x32_bf16 v[40:43], v[92:95], v[108:111], v[40:43]
    ds_read_b64_tr_b16 v[76:77], v14 offset:96
    ds_read_b64_tr_b16 v[78:79], v15 offset:96
    s_waitcnt lgkmcnt(11)
    v_mfma_f32_16x16x32_bf16 v[44:47], v[96:99], v[108:111], v[44:47]
    ds_read_b64_tr_b16 v[80:81], v14 offset:128
    ds_read_b64_tr_b16 v[82:83], v15 offset:128
    s_waitcnt lgkmcnt(11)
    v_mfma_f32_16x16x32_bf16 v[48:51], v[100:103], v[108:111], v[48:51]
    s_cbranch_scc1 L_c_17
L_rgr_16:
    s_mov_b32 s33, 0x3ea52b5c
    v_and_b32 v2, 31, v0
    v_lshrrev_b32 v3, 5, v1
    v_cmp_eq_u32 s[44:45], 1, v3
    v_lshlrev_b32 v6, 3, v2
    s_waitcnt lgkmcnt(0)
    v_mov_b32 v24, 896
    s_barrier
    v_mul_f32 v32, s33, v32
    v_mul_f32 v33, s33, v33
    v_mul_f32 v34, s33, v34
    v_mul_f32 v35, s33, v35
    v_cvt_pk_bf16_f32 v32, v32, v33
    v_cvt_pk_bf16_f32 v33, v34, v35
    ds_write_b64 v13, v[32:33] offset:0
    v_mul_f32 v36, s33, v36
    v_mul_f32 v37, s33, v37
    v_mul_f32 v38, s33, v38
    v_mul_f32 v39, s33, v39
    v_cvt_pk_bf16_f32 v36, v36, v37
    v_cvt_pk_bf16_f32 v37, v38, v39
    ds_write_b64 v13, v[36:37] offset:1024
    v_mul_f32 v40, s33, v40
    v_mul_f32 v41, s33, v41
    v_mul_f32 v42, s33, v42
    v_mul_f32 v43, s33, v43
    v_cvt_pk_bf16_f32 v40, v40, v41
    v_cvt_pk_bf16_f32 v41, v42, v43
    ds_write_b64 v13, v[40:41] offset:2048
    v_mul_f32 v44, s33, v44
    v_mul_f32 v45, s33, v45
    v_mul_f32 v46, s33, v46
    v_mul_f32 v47, s33, v47
    v_cvt_pk_bf16_f32 v44, v44, v45
    v_cvt_pk_bf16_f32 v45, v46, v47
    ds_write_b64 v13, v[44:45] offset:3072
    v_mul_f32 v48, s33, v48
    v_mul_f32 v49, s33, v49
    v_mul_f32 v50, s33, v50
    v_mul_f32 v51, s33, v51
    v_cvt_pk_bf16_f32 v48, v48, v49
    v_cvt_pk_bf16_f32 v49, v50, v51
    ds_write_b64 v13, v[48:49] offset:4096
    v_cndmask_b32 v21, v6, v24, s[44:45]
    s_mul_i32 s32, s29, 1280
    s_add_u32 s32, s32, 153600
    v_add_u32 v7, s32, v6
    v_lshl_add_u32 v6, v3, 9, v7
    v_mul_u32_u24 v23, 20, v3
    v_add_u32 v23, v23, v2
    v_cmp_gt_u32 vcc, 20, v2
    v_lshlrev_b32 v26, 3, v1
    s_nop 0
    v_cndmask_b32 v23, 40, v23, vcc
    v_lshlrev_b32 v23, 4, v23
    s_mov_b32 s36, 393216
    s_sub_u32 s37, s24, 5184
    s_cselect_b32 s37, 160704, s37
    s_add_u32 s38, s37, 2592
    s_waitcnt lgkmcnt(0)
    s_barrier
    buffer_load_dwordx2 v[24:25], v26, s[8:11], s36 offen sc1
    buffer_load_dwordx4 v[128:131], v5, s[8:11], s37 offen sc1
    buffer_load_dwordx2 v[132:133], v21, s[8:11], s37 offen offset:1024 sc1
    buffer_load_dwordx4 v[136:139], v5, s[8:11], s38 offen sc1
    buffer_load_dwordx2 v[140:141], v21, s[8:11], s38 offen offset:1024 sc1
    buffer_load_dwordx4 v[144:147], v23, s[8:11], s38 offen offset:1280 sc1
    buffer_load_dwordx4 v[148:151], v23, s[8:11], s38 offen offset:1936 sc1
    ds_read2_b64 v[8:11], v6 offset0:0 offset1:32
    ds_read_b64 v[12:13], v7 offset:1024
    v_add_u32 v6, 5120, v6
    ds_read2_b64 v[16:19], v6 offset0:0 offset1:32
    ds_read_b64 v[14:15], v7 offset:6144
    v_mov_b32 v20, v5
    v_cmp_lt_u32 vcc, 20, v2
    v_mov_b32 v6, 0x40000
    s_nop 0
    v_cndmask_b32 v22, v23, v6, vcc
    v_mov_b32 v4, 0xdddd
    v_mov_b32 v96, 0
    v_mov_b32 v97, 0
    v_mov_b32 v98, 0
    v_mov_b32 v99, 0
    v_mov_b32 v100, 0
    v_mov_b32 v101, 0
    v_mov_b32 v102, 0
    v_mov_b32 v103, 0
    v_mov_b32 v104, 0
    v_mov_b32 v105, 0
    v_mov_b32 v106, 0
    v_mov_b32 v107, 0
    v_mov_b32 v108, 0
    v_mov_b32 v109, 0
    v_mov_b32 v110, 0
    v_mov_b32 v111, 0
    v_mov_b32 v112, 0
    v_mov_b32 v113, 0
    v_mov_b32 v114, 0
    v_mov_b32 v115, 0
    v_mov_b32 v116, 0
    v_mov_b32 v117, 0
    v_mov_b32 v118, 0
    v_mov_b32 v119, 0
    v_mov_b32 v120, 0
    v_mov_b32 v121, 0
    v_mov_b32 v122, 0
    v_mov_b32 v123, 0
    v_mov_b32 v124, 0
    v_mov_b32 v125, 0
    v_mov_b32 v126, 0
    v_mov_b32 v127, 0
    v_mov_b32 v88, 0
    v_mov_b32 v89, 0
    v_mov_b32 v90, 0
    v_mov_b32 v91, 0
    v_mov_b32 v92, 0
    v_mov_b32 v93, 0
    v_mov_b32 v94, 0
    v_mov_b32 v95, 0
    v_mov_b32 v156, 0
    v_mov_b32 v157, 0
    v_mov_b32 v158, 0
    v_mov_b32 v159, 0
    v_mov_b32 v26, 0
    v_mov_b32 v28, 0
    v_mov_b32 v30, 163424
    s_lshl_b32 s32, s29, 3
    s_lshl_b32 s32, 1, s32
    v_mov_b32 v31, 0
    v_writelane_b32 v31, s32, 0
    s_waitcnt lgkmcnt(0)
    v_cndmask_b32 v12, v12, 0, s[44:45]
    v_cndmask_b32 v13, v13, 0, s[44:45]
    v_cndmask_b32 v14, v14, 0, s[44:45]
    v_cndmask_b32 v15, v15, 0, s[44:45]
    v_dot2c_f32_bf16 v26, v8, v8
    v_dot2c_f32_bf16 v28, v16, v16
    v_dot2c_f32_bf16 v26, v9, v9
    v_dot2c_f32_bf16 v28, v17, v17
    v_dot2c_f32_bf16 v26, v10, v10
    v_dot2c_f32_bf16 v28, v18, v18
    v_dot2c_f32_bf16 v26, v11, v11
    v_dot2c_f32_bf16 v28, v19, v19
    v_dot2c_f32_bf16 v26, v12, v12
    v_dot2c_f32_bf16 v28, v14, v14
    v_dot2c_f32_bf16 v26, v13, v13
    v_dot2c_f32_bf16 v28, v15, v15
    s_nop 2
    v_mov_b32 v27, v26
    v_mov_b32 v29, v28
    s_nop 1
    v_permlane32_swap_b32 v26, v27
    v_permlane32_swap_b32 v28, v29
    s_nop 1
    v_add_f32 v26, v26, v27
    v_add_f32 v28, v28, v29
    s_waitcnt vmcnt(6)
    v_max_u32 v24, v24, v25
    s_nop 1
    v_max_u32_dpp v24, v24, v24 row_ror:8 row_mask:0xf bank_mask:0xf
    s_nop 1
    v_max_u32_dpp v24, v24, v24 row_ror:4 row_mask:0xf bank_mask:0xf
    s_nop 1
    v_max_u32_dpp v24, v24, v24 row_ror:2 row_mask:0xf bank_mask:0xf
    s_nop 1
    v_max_u32_dpp v24, v24, v24 row_ror:1 row_mask:0xf bank_mask:0xf
    s_nop 1
    v_readlane_b32 s34, v24, 0
    v_readlane_b32 s35, v24, 16
    v_readlane_b32 s36, v24, 32
    v_readlane_b32 s37, v24, 48
    s_max_u32 s34, s34, s35
    s_max_u32 s36, s36, s37
    s_max_u32 s34, s34, s36
    v_mul_f32 v26, s34, v26
    v_mul_f32 v28, s34, v28
    v_sqrt_f32 v26, v26
    v_sqrt_f32 v28, v28
    s_nop 0
    v_mul_f32 v26, 0xbf820000, v26
    v_mul_f32 v28, 0xbf820000, v28
    v_lshrrev_b32 v26, 16, v26
    v_lshrrev_b32 v28, 16, v28
    v_cndmask_b32 v12, v12, v26, s[44:45]
    v_cndmask_b32 v14, v14, v28, s[44:45]
    s_waitcnt vmcnt(4)
    v_mfma_f32_32x32x8_bf16 v[32:47], v[132:133], v[12:13], 0
    v_mfma_f32_32x32x16_bf16 v[32:47], v[128:131], v[8:11], v[32:47]
    v_mfma_f32_32x32x8_bf16 v[48:63], v[132:133], v[14:15], 0
    v_mfma_f32_32x32x16_bf16 v[48:63], v[128:131], v[16:19], v[48:63]
    s_mov_b32 s46, 0
    s_waitcnt vmcnt(0)
    s_nop 7
L_sp_19:
    s_barrier
L_loop_18:
    v_exp_f32 v32, v32
    v_exp_f32 v33, v33
    v_smfmac_f32_32x32x32_bf16 v[112:127], v[156:159], v[88:95], v4
    s_waitcnt lgkmcnt(0)
    ds_read_b128 v[152:155], v22 offset:1280
    ds_read_b128 v[156:159], v22 offset:1936
    v_exp_f32 v34, v34
    v_exp_f32 v35, v35
    v_exp_f32 v36, v36
    v_exp_f32 v37, v37
    v_mfma_f32_32x32x8_bf16 v[64:79], v[140:141], v[12:13], 0
    v_exp_f32 v38, v38
    v_exp_f32 v39, v39
    v_exp_f32 v40, v40
    v_exp_f32 v41, v41
    v_mfma_f32_32x32x16_bf16 v[64:79], v[136:139], v[8:11], v[64:79]
    v_exp_f32 v42, v42
    v_exp_f32 v43, v43
    v_exp_f32 v44, v44
    v_exp_f32 v45, v45
    v_smfmac_f32_32x32x32_bf16 v[96:111], v[144:147], v[32:39], v4
    ds_read_b128 v[128:131], v20 offset:0
    ds_read_b64 v[132:133], v21 offset:1024
    v_exp_f32 v46, v46
    v_exp_f32 v47, v47
    v_exp_f32 v48, v48
    v_exp_f32 v49, v49
    v_smfmac_f32_32x32x32_bf16 v[96:111], v[148:151], v[40:47], v4
    v_exp_f32 v50, v50
    v_exp_f32 v51, v51
    v_exp_f32 v52, v52
    v_exp_f32 v53, v53
    v_mfma_f32_32x32x8_bf16 v[80:95], v[140:141], v[14:15], 0
    v_exp_f32 v54, v54
    v_exp_f32 v55, v55
    v_exp_f32 v56, v56
    v_exp_f32 v57, v57
    v_mfma_f32_32x32x16_bf16 v[80:95], v[136:139], v[16:19], v[80:95]
    v_exp_f32 v58, v58
    v_exp_f32 v59, v59
    v_exp_f32 v60, v60
    v_exp_f32 v61, v61
    v_smfmac_f32_32x32x32_bf16 v[112:127], v[144:147], v[48:55], v4
    v_exp_f32 v62, v62
    v_exp_f32 v63, v63
    v_exp_f32 v64, v64
    v_exp_f32 v65, v65
    v_smfmac_f32_32x32x32_bf16 v[112:127], v[148:151], v[56:63], v4
    s_waitcnt lgkmcnt(0)
    ds_read_b128 v[144:147], v22 offset:3872
    ds_read_b128 v[148:151], v22 offset:4528
    v_exp_f32 v66, v66
    v_exp_f32 v67, v67
    v_exp_f32 v68, v68
    v_exp_f32 v69, v69
    v_mfma_f32_32x32x8_bf16 v[32:47], v[132:133], v[12:13], 0
    v_exp_f32 v70, v70
    v_exp_f32 v71, v71
    v_exp_f32 v72, v72
    v_exp_f32 v73, v73
    v_mfma_f32_32x32x16_bf16 v[32:47], v[128:131], v[8:11], v[32:47]
    v_exp_f32 v74, v74
    v_exp_f32 v75, v75
    v_exp_f32 v76, v76
    v_exp_f32 v77, v77
    v_smfmac_f32_32x32x32_bf16 v[96:111], v[152:155], v[64:71], v4
    ds_read_b128 v[136:139], v20 offset:2592
    ds_read_b64 v[140:141], v21 offset:3616
    v_exp_f32 v78, v78
    v_exp_f32 v79, v79
    v_exp_f32 v80, v80
    v_exp_f32 v81, v81
    v_smfmac_f32_32x32x32_bf16 v[96:111], v[156:159], v[72:79], v4
    v_exp_f32 v82, v82
    v_exp_f32 v83, v83
    v_exp_f32 v84, v84
    v_exp_f32 v85, v85
    v_mfma_f32_32x32x8_bf16 v[48:63], v[132:133], v[14:15], 0
    v_exp_f32 v86, v86
    v_exp_f32 v87, v87
    v_exp_f32 v88, v88
    v_exp_f32 v89, v89
    v_mfma_f32_32x32x16_bf16 v[48:63], v[128:131], v[16:19], v[48:63]
    v_exp_f32 v90, v90
    v_exp_f32 v91, v91
    v_exp_f32 v92, v92
    v_exp_f32 v93, v93
    v_smfmac_f32_32x32x32_bf16 v[112:127], v[152:155], v[80:87], v4
    v_exp_f32 v94, v94
    v_exp_f32 v95, v95
    v_exp_f32 v32, v32
    v_exp_f32 v33, v33
    v_smfmac_f32_32x32x32_bf16 v[112:127], v[156:159], v[88:95], v4
    s_waitcnt lgkmcnt(0)
    ds_read_b128 v[152:155], v22 offset:6464
    ds_read_b128 v[156:159], v22 offset:7120
    v_exp_f32 v34, v34
    v_exp_f32 v35, v35
    v_exp_f32 v36, v36
    v_exp_f32 v37, v37
    v_mfma_f32_32x32x8_bf16 v[64:79], v[140:141], v[12:13], 0
    v_exp_f32 v38, v38
    v_exp_f32 v39, v39
    v_exp_f32 v40, v40
    v_exp_f32 v41, v41
    v_mfma_f32_32x32x16_bf16 v[64:79], v[136:139], v[8:11], v[64:79]
    v_exp_f32 v42, v42
    v_exp_f32 v43, v43
    v_exp_f32 v44, v44
    v_exp_f32 v45, v45
    v_smfmac_f32_32x32x32_bf16 v[96:111], v[144:147], v[32:39], v4
    ds_read_b128 v[128:131], v20 offset:5184
    ds_read_b64 v[132:133], v21 offset:6208
    v_exp_f32 v46, v46
    v_exp_f32 v47, v47
    v_exp_f32 v48, v48
    v_exp_f32 v49, v49
    v_smfmac_f32_32x32x32_bf16 v[96:111], v[148:151], v[40:47], v4
    v_exp_f32 v50, v50
    v_exp_f32 v51, v51
    v_exp_f32 v52, v52
    v_exp_f32 v53, v53
    v_mfma_f32_32x32x8_bf16 v[80:95], v[140:141], v[14:15], 0
    v_exp_f32 v54, v54
    v_exp_f32 v55, v55
    v_exp_f32 v56, v56
    v_exp_f32 v57, v57
    v_mfma_f32_32x32x16_bf16 v[80:95], v[136:139], v[16:19], v[80:95]
    v_exp_f32 v58, v58
    v_exp_f32 v59, v59
    v_exp_f32 v60, v60
    v_exp_f32 v61, v61
    v_smfmac_f32_32x32x32_bf16 v[112:127], v[144:147], v[48:55], v4
    v_exp_f32 v62, v62
    v_exp_f32 v63, v63
    v_exp_f32 v64, v64
    v_exp_f32 v65, v65
    v_smfmac_f32_32x32x32_bf16 v[112:127], v[148:151], v[56:63], v4
    s_waitcnt lgkmcnt(0)
    ds_read_b128 v[144:147], v22 offset:9056
    ds_read_b128 v[148:151], v22 offset:9712
    v_exp_f32 v66, v66
    v_exp_f32 v67, v67
    v_exp_f32 v68, v68
    v_exp_f32 v69, v69
    v_mfma_f32_32x32x8_bf16 v[32:47], v[132:133], v[12:13], 0
    v_exp_f32 v70, v70
    v_exp_f32 v71, v71
    v_exp_f32 v72, v72
    v_exp_f32 v73, v73
    v_mfma_f32_32x32x16_bf16 v[32:47], v[128:131], v[8:11], v[32:47]
    v_exp_f32 v74, v74
    v_exp_f32 v75, v75
    v_exp_f32 v76, v76
    v_exp_f32 v77, v77
    v_smfmac_f32_32x32x32_bf16 v[96:111], v[152:155], v[64:71], v4
    ds_read_b128 v[136:139], v20 offset:7776
    ds_read_b64 v[140:141], v21 offset:8800
    v_exp_f32 v78, v78
    v_exp_f32 v79, v79
    v_exp_f32 v80, v80
    v_exp_f32 v81, v81
    v_smfmac_f32_32x32x32_bf16 v[96:111], v[156:159], v[72:79], v4
    v_exp_f32 v82, v82
    v_exp_f32 v83, v83
    v_exp_f32 v84, v84
    v_exp_f32 v85, v85
    v_mfma_f32_32x32x8_bf16 v[48:63], v[132:133], v[14:15], 0
    v_exp_f32 v86, v86
    v_exp_f32 v87, v87
    v_exp_f32 v88, v88
    v_exp_f32 v89, v89
    v_mfma_f32_32x32x16_bf16 v[48:63], v[128:131], v[16:19], v[48:63]
    v_exp_f32 v90, v90
    v_exp_f32 v91, v91
    v_exp_f32 v92, v92
    v_exp_f32 v93, v93
    v_smfmac_f32_32x32x32_bf16 v[112:127], v[152:155], v[80:87], v4
    v_exp_f32 v94, v94
    v_exp_f32 v95, v95
    v_exp_f32 v32, v32
    v_exp_f32 v33, v33
    v_smfmac_f32_32x32x32_bf16 v[112:127], v[156:159], v[88:95], v4
    s_waitcnt lgkmcnt(0)
    ds_read_b128 v[152:155], v22 offset:11648
    ds_read_b128 v[156:159], v22 offset:12304
    v_exp_f32 v34, v34
    v_exp_f32 v35, v35
    v_exp_f32 v36, v36
    v_exp_f32 v37, v37
    v_mfma_f32_32x32x8_bf16 v[64:79], v[140:141], v[12:13], 0
    v_exp_f32 v38, v38
    v_exp_f32 v39, v39
    v_exp_f32 v40, v40
    v_exp_f32 v41, v41
    v_mfma_f32_32x32x16_bf16 v[64:79], v[136:139], v[8:11], v[64:79]
    v_exp_f32 v42, v42
    v_exp_f32 v43, v43
    v_exp_f32 v44, v44
    v_exp_f32 v45, v45
    v_smfmac_f32_32x32x32_bf16 v[96:111], v[144:147], v[32:39], v4
    ds_read_b128 v[128:131], v20 offset:10368
    ds_read_b64 v[132:133], v21 offset:11392
    v_exp_f32 v46, v46
    v_exp_f32 v47, v47
    v_exp_f32 v48, v48
    v_exp_f32 v49, v49
    v_smfmac_f32_32x32x32_bf16 v[96:111], v[148:151], v[40:47], v4
    v_exp_f32 v50, v50
    v_exp_f32 v51, v51
    v_exp_f32 v52, v52
    v_exp_f32 v53, v53
    v_mfma_f32_32x32x8_bf16 v[80:95], v[140:141], v[14:15], 0
    v_exp_f32 v54, v54
    v_exp_f32 v55, v55
    v_exp_f32 v56, v56
    v_exp_f32 v57, v57
    v_mfma_f32_32x32x16_bf16 v[80:95], v[136:139], v[16:19], v[80:95]
    v_exp_f32 v58, v58
    v_exp_f32 v59, v59
    v_exp_f32 v60, v60
    v_exp_f32 v61, v61
    v_smfmac_f32_32x32x32_bf16 v[112:127], v[144:147], v[48:55], v4
    v_exp_f32 v62, v62
    v_exp_f32 v63, v63
    v_exp_f32 v64, v64
    v_exp_f32 v65, v65
    v_smfmac_f32_32x32x32_bf16 v[112:127], v[148:151], v[56:63], v4
    s_waitcnt lgkmcnt(0)
    ds_read_b128 v[144:147], v22 offset:14240
    ds_read_b128 v[148:151], v22 offset:14896
    v_exp_f32 v66, v66
    v_exp_f32 v67, v67
    v_exp_f32 v68, v68
    v_exp_f32 v69, v69
    v_mfma_f32_32x32x8_bf16 v[32:47], v[132:133], v[12:13], 0
    v_exp_f32 v70, v70
    v_exp_f32 v71, v71
    v_exp_f32 v72, v72
    v_exp_f32 v73, v73
    v_mfma_f32_32x32x16_bf16 v[32:47], v[128:131], v[8:11], v[32:47]
    v_exp_f32 v74, v74
    v_exp_f32 v75, v75
    v_exp_f32 v76, v76
    v_exp_f32 v77, v77
    v_smfmac_f32_32x32x32_bf16 v[96:111], v[152:155], v[64:71], v4
    ds_read_b128 v[136:139], v20 offset:12960
    ds_read_b64 v[140:141], v21 offset:13984
    v_exp_f32 v78, v78
    v_exp_f32 v79, v79
    v_exp_f32 v80, v80
    v_exp_f32 v81, v81
    v_smfmac_f32_32x32x32_bf16 v[96:111], v[156:159], v[72:79], v4
    v_exp_f32 v82, v82
    v_exp_f32 v83, v83
    v_exp_f32 v84, v84
    v_exp_f32 v85, v85
    v_mfma_f32_32x32x8_bf16 v[48:63], v[132:133], v[14:15], 0
    v_exp_f32 v86, v86
    v_exp_f32 v87, v87
    v_exp_f32 v88, v88
    v_exp_f32 v89, v89
    v_mfma_f32_32x32x16_bf16 v[48:63], v[128:131], v[16:19], v[48:63]
    v_exp_f32 v90, v90
    v_exp_f32 v91, v91
    v_exp_f32 v92, v92
    v_exp_f32 v93, v93
    v_smfmac_f32_32x32x32_bf16 v[112:127], v[152:155], v[80:87], v4
    v_exp_f32 v94, v94
    v_exp_f32 v95, v95
    v_exp_f32 v32, v32
    v_exp_f32 v33, v33
    v_smfmac_f32_32x32x32_bf16 v[112:127], v[156:159], v[88:95], v4
    s_waitcnt lgkmcnt(0)
    ds_read_b128 v[152:155], v22 offset:16832
    ds_read_b128 v[156:159], v22 offset:17488
    v_exp_f32 v34, v34
    v_exp_f32 v35, v35
    v_exp_f32 v36, v36
    v_exp_f32 v37, v37
    v_mfma_f32_32x32x8_bf16 v[64:79], v[140:141], v[12:13], 0
    v_exp_f32 v38, v38
    v_exp_f32 v39, v39
    v_exp_f32 v40, v40
    v_exp_f32 v41, v41
    v_mfma_f32_32x32x16_bf16 v[64:79], v[136:139], v[8:11], v[64:79]
    v_exp_f32 v42, v42
    v_exp_f32 v43, v43
    v_exp_f32 v44, v44
    v_exp_f32 v45, v45
    v_smfmac_f32_32x32x32_bf16 v[96:111], v[144:147], v[32:39], v4
    ds_read_b128 v[128:131], v20 offset:15552
    ds_read_b64 v[132:133], v21 offset:16576
    v_exp_f32 v46, v46
    v_exp_f32 v47, v47
    v_exp_f32 v48, v48
    v_exp_f32 v49, v49
    v_smfmac_f32_32x32x32_bf16 v[96:111], v[148:151], v[40:47], v4
    v_exp_f32 v50, v50
    v_exp_f32 v51, v51
    v_exp_f32 v52, v52
    v_exp_f32 v53, v53
    v_mfma_f32_32x32x8_bf16 v[80:95], v[140:141], v[14:15], 0
    v_exp_f32 v54, v54
    v_exp_f32 v55, v55
    v_exp_f32 v56, v56
    v_exp_f32 v57, v57
    v_mfma_f32_32x32x16_bf16 v[80:95], v[136:139], v[16:19], v[80:95]
    v_exp_f32 v58, v58
    v_exp_f32 v59, v59
    v_exp_f32 v60, v60
    v_exp_f32 v61, v61
    v_smfmac_f32_32x32x32_bf16 v[112:127], v[144:147], v[48:55], v4
    v_exp_f32 v62, v62
    v_exp_f32 v63, v63
    v_exp_f32 v64, v64
    v_exp_f32 v65, v65
    v_smfmac_f32_32x32x32_bf16 v[112:127], v[148:151], v[56:63], v4
    s_waitcnt lgkmcnt(0)
    ds_read_b128 v[144:147], v22 offset:19424
    ds_read_b128 v[148:151], v22 offset:20080
    v_exp_f32 v66, v66
    v_exp_f32 v67, v67
    v_exp_f32 v68, v68
    v_exp_f32 v69, v69
    v_mfma_f32_32x32x8_bf16 v[32:47], v[132:133], v[12:13], 0
    v_exp_f32 v70, v70
    v_exp_f32 v71, v71
    v_exp_f32 v72, v72
    v_exp_f32 v73, v73
    v_mfma_f32_32x32x16_bf16 v[32:47], v[128:131], v[8:11], v[32:47]
    v_exp_f32 v74, v74
    v_exp_f32 v75, v75
    v_exp_f32 v76, v76
    v_exp_f32 v77, v77
    v_smfmac_f32_32x32x32_bf16 v[96:111], v[152:155], v[64:71], v4
    ds_read_b128 v[136:139], v20 offset:18144
    ds_read_b64 v[140:141], v21 offset:19168
    ds_read_b32 v24, v30 offset:16
    v_exp_f32 v78, v78
    v_exp_f32 v79, v79
    v_exp_f32 v80, v80
    v_exp_f32 v81, v81
    v_smfmac_f32_32x32x32_bf16 v[96:111], v[156:159], v[72:79], v4
    v_exp_f32 v82, v82
    v_exp_f32 v83, v83
    v_exp_f32 v84, v84
    v_exp_f32 v85, v85
    v_mfma_f32_32x32x8_bf16 v[48:63], v[132:133], v[14:15], 0
    v_exp_f32 v86, v86
    v_exp_f32 v87, v87
    v_exp_f32 v88, v88
    v_exp_f32 v89, v89
    v_mfma_f32_32x32x16_bf16 v[48:63], v[128:131], v[16:19], v[48:63]
    v_exp_f32 v90, v90
    v_exp_f32 v91, v91
    v_exp_f32 v92, v92
    v_exp_f32 v93, v93
    v_smfmac_f32_32x32x32_bf16 v[112:127], v[152:155], v[80:87], v4
    s_add_u32 s46, s46, 1
    s_bitcmp1_b32 0x12e, s46
    v_add_u32 v20, 20736, v20
    v_add_u32 v21, 20736, v21
    v_add_u32 v22, 20736, v22
    v_exp_f32 v94, v94
    v_exp_f32 v95, v95
    s_cbranch_scc0 L_loop_18
    s_cmp_eq_u32 s46, 1
    s_cbranch_scc1 L_sp_19
    s_waitcnt lgkmcnt(0)
    v_readfirstlane_b32 s32, v24
    s_mov_b64 exec, 1
    ds_add_u32 v30, v31 offset:4
    s_mov_b64 exec, -1
    s_cmp_lt_u32 s32, 4
    s_cbranch_scc1 L_kr_20
    s_cmp_lt_u32 s46, 8
    s_cbranch_scc1 L_loop_18
    v_smfmac_f32_32x32x32_bf16 v[112:127], v[156:159], v[88:95], v4
    v_mov_b32 v26, 0x30800000
    s_nop 1
    v_rcp_f32 v28, v104
    s_nop 0
    v_mov_b32 v29, v28
    s_nop 1
    v_permlane32_swap_b32 v28, v29
    s_nop 3
    v_min_f32 v27, v104, v120
    v_cmp_nge_f32 vcc, v27, v26
    v_cmp_u_f32 s[36:37], v104, v120
    s_or_b64 vcc, vcc, s[36:37]
    s_and_b64 vcc, vcc, s[44:45]
    s_cbranch_vccnz L_fb_21
L_norm_22:
    v_rcp_f32 v26, v120
    v_mul_f32 v96, v96, v29
    v_mul_f32 v97, v97, v29
    v_mul_f32 v98, v98, v29
    v_mul_f32 v99, v99, v29
    v_mul_f32 v100, v100, v29
    v_mul_f32 v101, v101, v29
    v_mul_f32 v102, v102, v29
    v_mul_f32 v103, v103, v29
    v_mul_f32 v104, v104, v29
    v_mul_f32 v105, v105, v29
    v_mul_f32 v106, v106, v29
    v_mul_f32 v107, v107, v29
    v_mov_b32 v27, v26
    v_cvt_pk_bf16_f32 v32, v96, v97
    v_cvt_pk_bf16_f32 v33, v98, v99
    v_cvt_pk_bf16_f32 v34, v100, v101
    v_cvt_pk_bf16_f32 v35, v102, v103
    v_cvt_pk_bf16_f32 v36, v104, v105
    v_cvt_pk_bf16_f32 v37, v106, v107
    v_permlane32_swap_b32 v26, v27
    buffer_store_dwordx4 v[32:35], v169, s[8:11], s74 offen sc1
    buffer_store_dwordx2 v[36:37], v170, s[8:11], s75 offen sc1
    v_mul_f32 v112, v112, v27
    v_mul_f32 v113, v113, v27
    v_mul_f32 v114, v114, v27
    v_mul_f32 v115, v115, v27
    v_mul_f32 v116, v116, v27
    v_mul_f32 v117, v117, v27
    v_mul_f32 v118, v118, v27
    v_mul_f32 v119, v119, v27
    v_mul_f32 v120, v120, v27
    v_mul_f32 v121, v121, v27
    v_mul_f32 v122, v122, v27
    v_mul_f32 v123, v123, v27
    v_cvt_pk_bf16_f32 v40, v112, v113
    v_cvt_pk_bf16_f32 v41, v114, v115
    v_cvt_pk_bf16_f32 v42, v116, v117
    v_cvt_pk_bf16_f32 v43, v118, v119
    v_cvt_pk_bf16_f32 v44, v120, v121
    v_cvt_pk_bf16_f32 v45, v122, v123
    buffer_store_dwordx4 v[40:43], v169, s[8:11], s58 offen sc1
    buffer_store_dwordx2 v[44:45], v170, s[8:11], s59 offen sc1
    s_barrier
L_oproj_3:
    ds_read_b64_tr_b16 v[96:97], v161 offset:0
    ds_read_b64_tr_b16 v[98:99], v161 offset:3200
    ds_read_b64_tr_b16 v[100:101], v161 offset:32
    ds_read_b64_tr_b16 v[102:103], v161 offset:3232
    ds_read_b64_tr_b16 v[104:105], v161 offset:64
    ds_read_b64_tr_b16 v[106:107], v161 offset:3264
    ds_read_b64_tr_b16 v[108:109], v161 offset:96
    ds_read_b64_tr_b16 v[110:111], v161 offset:3296
    ds_read_b64_tr_b16 v[112:113], v161 offset:128
    ds_read_b64_tr_b16 v[114:115], v161 offset:3328
    ds_read_b64_tr_b16 v[116:117], v161 offset:25600
    ds_read_b64_tr_b16 v[118:119], v161 offset:28800
    ds_read_b64_tr_b16 v[120:121], v161 offset:25632
    ds_read_b64_tr_b16 v[122:123], v161 offset:28832
    ds_read_b64_tr_b16 v[124:125], v161 offset:25664
    ds_read_b64_tr_b16 v[126:127], v161 offset:28864
    ds_read_b64_tr_b16 v[128:129], v161 offset:25696
    ds_read_b64_tr_b16 v[130:131], v161 offset:28896
    ds_read_b64_tr_b16 v[132:133], v161 offset:25728
    ds_read_b64_tr_b16 v[134:135], v161 offset:28928
    ds_read_b64_tr_b16 v[136:137], v160 offset:0
    ds_read_b64_tr_b16 v[138:139], v160 offset:1280
    ds_read_b64_tr_b16 v[140:141], v160 offset:32
    ds_read_b64_tr_b16 v[142:143], v160 offset:1312
    ds_read_b64_tr_b16 v[144:145], v160 offset:64
    ds_read_b64_tr_b16 v[146:147], v160 offset:1344
    ds_read_b64_tr_b16 v[148:149], v160 offset:96
    ds_read_b64_tr_b16 v[150:151], v160 offset:1376
    ds_read_b64_tr_b16 v[152:153], v160 offset:128
    ds_read_b64_tr_b16 v[154:155], v160 offset:1408
    ds_read_b64_tr_b16 v[156:157], v160 offset:6400
    ds_read_b64_tr_b16 v[158:159], v160 offset:7680
    ds_read_b64_tr_b16 v[176:177], v160 offset:6432
    ds_read_b64_tr_b16 v[178:179], v160 offset:7712
    ds_read_b64_tr_b16 v[180:181], v160 offset:6464
    ds_read_b64_tr_b16 v[182:183], v160 offset:7744
    ds_read_b64_tr_b16 v[184:185], v160 offset:6496
    ds_read_b64_tr_b16 v[186:187], v160 offset:7776
    ds_read_b64_tr_b16 v[188:189], v160 offset:6528
    ds_read_b64_tr_b16 v[190:191], v160 offset:7808
    ds_read_b64_tr_b16 v[192:193], v160 offset:12800
    ds_read_b64_tr_b16 v[194:195], v160 offset:14080
    ds_read_b64_tr_b16 v[196:197], v160 offset:12832
    ds_read_b64_tr_b16 v[198:199], v160 offset:14112
    ds_read_b64_tr_b16 v[200:201], v160 offset:12864
    ds_read_b64_tr_b16 v[202:203], v160 offset:14144
    ds_read_b64_tr_b16 v[204:205], v160 offset:12896
    ds_read_b64_tr_b16 v[206:207], v160 offset:14176
    ds_read_b64_tr_b16 v[208:209], v160 offset:12928
    ds_read_b64_tr_b16 v[210:211], v160 offset:14208
    ds_read_b64_tr_b16 v[212:213], v160 offset:19200
    ds_read_b64_tr_b16 v[214:215], v160 offset:20480
    ds_read_b64_tr_b16 v[216:217], v160 offset:19232
    ds_read_b64_tr_b16 v[218:219], v160 offset:20512
    ds_read_b64_tr_b16 v[220:221], v160 offset:19264
    ds_read_b64_tr_b16 v[222:223], v160 offset:20544
    ds_read_b64_tr_b16 v[224:225], v160 offset:19296
    ds_read_b64_tr_b16 v[226:227], v160 offset:20576
    ds_read_b64_tr_b16 v[228:229], v160 offset:19328
    ds_read_b64_tr_b16 v[230:231], v160 offset:20608
    ds_read_b64_tr_b16 v[232:233], v160 offset:25600
    ds_read_b64_tr_b16 v[234:235], v160 offset:26880
    ds_read_b64_tr_b16 v[236:237], v160 offset:25632
    ds_read_b64_tr_b16 v[238:239], v160 offset:26912
    ds_read_b64_tr_b16 v[240:241], v160 offset:25664
    ds_read_b64_tr_b16 v[242:243], v160 offset:26944
    ds_read_b64_tr_b16 v[244:245], v160 offset:25696
    ds_read_b64_tr_b16 v[246:247], v160 offset:26976
    ds_read_b64_tr_b16 v[248:249], v160 offset:25728
    ds_read_b64_tr_b16 v[250:251], v160 offset:27008
    s_mov_b32 s20, s4
    s_and_b32 s21, s5, 0xffff
    v_lshlrev_b32 v6, 2, v163
    s_mov_b32 s32, 405504
    buffer_load_dword v48, v6, s[8:11], s32 offen sc1
    buffer_load_dword v49, v6, s[8:11], s32 offen offset:16 sc1
    buffer_load_dwordx4 v[28:31], v162, s[20:23], 0 offen
    buffer_load_dwordx4 v[32:35], v162, s[20:23], s55 offen
    s_mov_b32 s46, 100000
    s_mov_b32 s71, -1
    s_mov_b32 s47, 0
    s_cmp_lg_u32 s72, 0
    s_cbranch_scc1 L_h2_54
    s_waitcnt vmcnt(4)
    s_barrier
    s_waitcnt vmcnt(0)
    v_cvt_pk_bf16_f32 v48, v48, v48
    v_and_b32 v48, 0xffff0000, v48
    v_mul_f32 v50, 0xbfb8aa3b, v48
    v_exp_f32 v50, v50
    s_nop 0
    v_add_f32 v50, 1.0, v50
    v_rcp_f32 v48, v50
    s_nop 0
    v_cvt_pk_bf16_f32 v48, v48, v48
    v_and_b32 v48, 0xffff0000, v48
    v_cvt_pk_bf16_f32 v49, v49, v49
    v_and_b32 v49, 0xffff0000, v49
    v_mul_f32 v50, 0xbfb8aa3b, v49
    v_exp_f32 v50, v50
    s_nop 0
    v_add_f32 v50, 1.0, v50
    v_rcp_f32 v49, v50
    s_nop 0
    v_cvt_pk_bf16_f32 v49, v49, v49
    v_and_b32 v49, 0xffff0000, v49
    v_sub_f32 v50, 1.0, v48
    v_cvt_pk_bf16_f32 v50, v50, v50
    v_and_b32 v50, 0xffff0000, v50
    v_sub_f32 v51, 1.0, v49
    v_cvt_pk_bf16_f32 v51, v51, v51
    v_and_b32 v51, 0xffff0000, v51
    v_lshlrev_b32 v36, 16, v28
    v_and_b32 v37, 0xffff0000, v28
    v_lshlrev_b32 v38, 16, v29
    v_and_b32 v39, 0xffff0000, v29
    v_lshlrev_b32 v40, 16, v30
    v_and_b32 v41, 0xffff0000, v30
    v_lshlrev_b32 v42, 16, v31
    v_and_b32 v43, 0xffff0000, v31
    v_lshlrev_b32 v44, 16, v32
    v_and_b32 v45, 0xffff0000, v32
    v_lshlrev_b32 v46, 16, v33
    v_and_b32 v47, 0xffff0000, v33
    v_lshlrev_b32 v52, 16, v34
    v_and_b32 v53, 0xffff0000, v34
    v_lshlrev_b32 v54, 16, v35
    v_and_b32 v55, 0xffff0000, v35
    s_mov_b32 s20, s6
    s_and_b32 s21, s7, 0xffff
L_h3_55:
    v_mov_b32 v6, 163424
    ds_read_b32 v6, v6 offset:12
    s_waitcnt lgkmcnt(0)
    v_readfirstlane_b32 s56, v6
    s_lshr_b32 s33, s52, 3
    s_lshr_b32 s32, s56, 3
    s_cmp_eq_u32 s32, s33
    s_cbranch_scc1 L_sel_60
L_nosel_61:
    v_pk_mul_f32 v[36:37], v[36:37], v[50:51] op_sel:[0,0] op_sel_hi:[1,0]
    v_pk_mul_f32 v[38:39], v[38:39], v[50:51] op_sel:[0,0] op_sel_hi:[1,0]
    v_pk_mul_f32 v[40:41], v[40:41], v[50:51] op_sel:[0,0] op_sel_hi:[1,0]
    v_pk_mul_f32 v[42:43], v[42:43], v[50:51] op_sel:[0,0] op_sel_hi:[1,0]
    v_pk_mul_f32 v[44:45], v[44:45], v[50:51] op_sel:[0,1] op_sel_hi:[1,1]
    v_pk_mul_f32 v[46:47], v[46:47], v[50:51] op_sel:[0,1] op_sel_hi:[1,1]
    v_pk_mul_f32 v[52:53], v[52:53], v[50:51] op_sel:[0,1] op_sel_hi:[1,1]
    v_pk_mul_f32 v[54:55], v[54:55], v[50:51] op_sel:[0,1] op_sel_hi:[1,1]
    s_cmp_eq_u32 s72, 0
    s_cbranch_scc1 L_rl_57
    s_barrier
L_rl_57:
    buffer_load_dwordx2 v[56:57], v164, s[8:11], s70 offen sc1
    buffer_load_dwordx2 v[58:59], v164, s[8:11], s70 offen offset:128 sc1
    buffer_load_dwordx2 v[60:61], v165, s[8:11], s70 offen sc1
    buffer_load_dwordx2 v[62:63], v165, s[8:11], s70 offen offset:128 sc1
    buffer_load_dwordx4 v[64:67], v5, s[8:11], s12 offen sc1
    buffer_load_dwordx4 v[68:71], v5, s[8:11], s13 offen sc1
    buffer_load_dwordx4 v[72:75], v5, s[8:11], s14 offen sc1
    buffer_load_dwordx4 v[76:79], v5, s[8:11], s15 offen sc1
    buffer_load_dwordx4 v[80:83], v5, s[8:11], s16 offen sc1
    buffer_load_dwordx4 v[84:87], v5, s[8:11], s17 offen sc1
    buffer_load_dwordx4 v[88:91], v5, s[8:11], s18 offen sc1
    buffer_load_dwordx4 v[92:95], v5, s[8:11], s19 offen sc1
L_mm_58:
    s_waitcnt vmcnt(8)
    v_max3_u32 v6, v56, v57, v58
    v_max3_u32 v6, v59, v60, v6
    v_max3_u32 v6, v61, v62, v6
    v_max_u32 v6, v63, v6
    v_cmp_eq_u32 vcc, s71, v6
    s_cbranch_vccnz L_et_62
L_mm2_63:
    s_waitcnt vmcnt(8) lgkmcnt(0)
    v_mfma_f32_16x16x32_bf16 v[8:11], v[96:99], v[56:59], 0
    v_mfma_f32_16x16x32_bf16 v[12:15], v[100:103], v[56:59], 0
    ds_read_b64_tr_b16 v[96:97], v160 offset:32000
    ds_read_b64_tr_b16 v[98:99], v160 offset:33280
    v_mfma_f32_16x16x32_bf16 v[16:19], v[104:107], v[56:59], 0
    ds_read_b64_tr_b16 v[100:101], v160 offset:32032
    ds_read_b64_tr_b16 v[102:103], v160 offset:33312
    v_mfma_f32_16x16x32_bf16 v[20:23], v[108:111], v[56:59], 0
    ds_read_b64_tr_b16 v[104:105], v160 offset:32064
    ds_read_b64_tr_b16 v[106:107], v160 offset:33344
    v_mfma_f32_16x16x32_bf16 v[24:27], v[112:115], v[56:59], 0
    ds_read_b64_tr_b16 v[108:109], v160 offset:32096
    ds_read_b64_tr_b16 v[110:111], v160 offset:33376
    ds_read_b64_tr_b16 v[112:113], v160 offset:32128
    ds_read_b64_tr_b16 v[114:115], v160 offset:33408
    s_waitcnt vmcnt(8)
    v_mfma_f32_16x16x32_bf16 v[8:11], v[116:119], v[60:63], v[8:11]
    v_mfma_f32_16x16x32_bf16 v[12:15], v[120:123], v[60:63], v[12:15]
    ds_read_b64_tr_b16 v[116:117], v160 offset:38400
    ds_read_b64_tr_b16 v[118:119], v160 offset:39680
    v_mfma_f32_16x16x32_bf16 v[16:19], v[124:127], v[60:63], v[16:19]
    ds_read_b64_tr_b16 v[120:121], v160 offset:38432
    ds_read_b64_tr_b16 v[122:123], v160 offset:39712
    v_mfma_f32_16x16x32_bf16 v[20:23], v[128:131], v[60:63], v[20:23]
    ds_read_b64_tr_b16 v[124:125], v160 offset:38464
    ds_read_b64_tr_b16 v[126:127], v160 offset:39744
    v_mfma_f32_16x16x32_bf16 v[24:27], v[132:135], v[60:63], v[24:27]
    ds_read_b64_tr_b16 v[128:129], v160 offset:38496
    ds_read_b64_tr_b16 v[130:131], v160 offset:39776
    ds_read_b64_tr_b16 v[132:133], v160 offset:38528
    ds_read_b64_tr_b16 v[134:135], v160 offset:39808
    s_waitcnt vmcnt(7)
    v_mfma_f32_16x16x32_bf16 v[8:11], v[136:139], v[64:67], v[8:11]
    v_max3_u32 v6, v64, v65, v6
    v_mfma_f32_16x16x32_bf16 v[12:15], v[140:143], v[64:67], v[12:15]
    v_max3_u32 v6, v66, v67, v6
    ds_read_b64_tr_b16 v[136:137], v160 offset:44800
    ds_read_b64_tr_b16 v[138:139], v160 offset:46080
    v_mfma_f32_16x16x32_bf16 v[16:19], v[144:147], v[64:67], v[16:19]
    ds_read_b64_tr_b16 v[140:141], v160 offset:44832
    ds_read_b64_tr_b16 v[142:143], v160 offset:46112
    v_mfma_f32_16x16x32_bf16 v[20:23], v[148:151], v[64:67], v[20:23]
    ds_read_b64_tr_b16 v[144:145], v160 offset:44864
    ds_read_b64_tr_b16 v[146:147], v160 offset:46144
    v_mfma_f32_16x16x32_bf16 v[24:27], v[152:155], v[64:67], v[24:27]
    ds_read_b64_tr_b16 v[148:149], v160 offset:44896
    ds_read_b64_tr_b16 v[150:151], v160 offset:46176
    ds_read_b64_tr_b16 v[152:153], v160 offset:44928
    ds_read_b64_tr_b16 v[154:155], v160 offset:46208
    s_waitcnt vmcnt(6)
    v_mfma_f32_16x16x32_bf16 v[8:11], v[156:159], v[68:71], v[8:11]
    v_max3_u32 v6, v68, v69, v6
    v_mfma_f32_16x16x32_bf16 v[12:15], v[176:179], v[68:71], v[12:15]
    v_max3_u32 v6, v70, v71, v6
    v_mfma_f32_16x16x32_bf16 v[16:19], v[180:183], v[68:71], v[16:19]
    v_mfma_f32_16x16x32_bf16 v[20:23], v[184:187], v[68:71], v[20:23]
    v_mfma_f32_16x16x32_bf16 v[24:27], v[188:191], v[68:71], v[24:27]
    s_waitcnt vmcnt(5)
    v_mfma_f32_16x16x32_bf16 v[8:11], v[192:195], v[72:75], v[8:11]
    v_max3_u32 v6, v72, v73, v6
    v_mfma_f32_16x16x32_bf16 v[12:15], v[196:199], v[72:75], v[12:15]
    v_max3_u32 v6, v74, v75, v6
    v_mfma_f32_16x16x32_bf16 v[16:19], v[200:203], v[72:75], v[16:19]
    v_mfma_f32_16x16x32_bf16 v[20:23], v[204:207], v[72:75], v[20:23]
    v_mfma_f32_16x16x32_bf16 v[24:27], v[208:211], v[72:75], v[24:27]
    s_waitcnt vmcnt(4)
    v_mfma_f32_16x16x32_bf16 v[8:11], v[212:215], v[76:79], v[8:11]
    v_max3_u32 v6, v76, v77, v6
    v_mfma_f32_16x16x32_bf16 v[12:15], v[216:219], v[76:79], v[12:15]
    v_max3_u32 v6, v78, v79, v6
    v_mfma_f32_16x16x32_bf16 v[16:19], v[220:223], v[76:79], v[16:19]
    v_mfma_f32_16x16x32_bf16 v[20:23], v[224:227], v[76:79], v[20:23]
    v_mfma_f32_16x16x32_bf16 v[24:27], v[228:231], v[76:79], v[24:27]
    s_waitcnt vmcnt(3)
    v_mfma_f32_16x16x32_bf16 v[8:11], v[232:235], v[80:83], v[8:11]
    v_max3_u32 v6, v80, v81, v6
    v_mfma_f32_16x16x32_bf16 v[12:15], v[236:239], v[80:83], v[12:15]
    v_max3_u32 v6, v82, v83, v6
    v_mfma_f32_16x16x32_bf16 v[16:19], v[240:243], v[80:83], v[16:19]
    v_mfma_f32_16x16x32_bf16 v[20:23], v[244:247], v[80:83], v[20:23]
    v_mfma_f32_16x16x32_bf16 v[24:27], v[248:251], v[80:83], v[24:27]
    s_waitcnt vmcnt(2) lgkmcnt(0)
    v_mfma_f32_16x16x32_bf16 v[8:11], v[96:99], v[84:87], v[8:11]
    v_max3_u32 v6, v84, v85, v6
    v_mfma_f32_16x16x32_bf16 v[12:15], v[100:103], v[84:87], v[12:15]
    v_max3_u32 v6, v86, v87, v6
    v_mfma_f32_16x16x32_bf16 v[16:19], v[104:107], v[84:87], v[16:19]
    v_mfma_f32_16x16x32_bf16 v[20:23], v[108:111], v[84:87], v[20:23]
    v_mfma_f32_16x16x32_bf16 v[24:27], v[112:115], v[84:87], v[24:27]
    s_waitcnt vmcnt(1)
    v_mfma_f32_16x16x32_bf16 v[8:11], v[116:119], v[88:91], v[8:11]
    v_max3_u32 v6, v88, v89, v6
    v_mfma_f32_16x16x32_bf16 v[12:15], v[120:123], v[88:91], v[12:15]
    v_max3_u32 v6, v90, v91, v6
    v_mfma_f32_16x16x32_bf16 v[16:19], v[124:127], v[88:91], v[16:19]
    v_mfma_f32_16x16x32_bf16 v[20:23], v[128:131], v[88:91], v[20:23]
    v_mfma_f32_16x16x32_bf16 v[24:27], v[132:135], v[88:91], v[24:27]
    s_waitcnt vmcnt(0)
    v_mfma_f32_16x16x32_bf16 v[8:11], v[136:139], v[92:95], v[8:11]
    v_max3_u32 v6, v92, v93, v6
    v_mfma_f32_16x16x32_bf16 v[12:15], v[140:143], v[92:95], v[12:15]
    v_max3_u32 v6, v94, v95, v6
    v_mfma_f32_16x16x32_bf16 v[16:19], v[144:147], v[92:95], v[16:19]
    v_mfma_f32_16x16x32_bf16 v[20:23], v[148:151], v[92:95], v[20:23]
    v_mfma_f32_16x16x32_bf16 v[24:27], v[152:155], v[92:95], v[24:27]
    v_cmp_eq_u32 vcc, s71, v6
    s_cbranch_vccnz L_rt_59
    s_nop 1
    ds_write_b128 v168, v[8:11] offset:0
    s_nop 3
    ds_write_b128 v168, v[12:15] offset:64
    ds_write_b128 v168, v[16:19] offset:128
    ds_write_b128 v168, v[20:23] offset:192
    ds_write_b128 v168, v[24:27] offset:256
    s_waitcnt lgkmcnt(0)
    s_barrier
    ds_read_b128 v[96:99], v166 offset:0
    ds_read_b128 v[100:103], v166 offset:16
    ds_read_b128 v[104:107], v166 offset:21504
    ds_read_b128 v[108:111], v166 offset:21520
    ds_read_b128 v[112:115], v166 offset:1344
    ds_read_b128 v[116:119], v166 offset:1360
    ds_read_b128 v[120:123], v166 offset:22848
    ds_read_b128 v[124:127], v166 offset:22864
    s_waitcnt lgkmcnt(4)
    v_pk_add_f32 v[96:97], v[96:97], v[104:105]
    v_pk_add_f32 v[98:99], v[98:99], v[106:107]
    v_pk_add_f32 v[100:101], v[100:101], v[108:109]
    v_pk_add_f32 v[102:103], v[102:103], v[110:111]
    v_pk_fma_f32 v[36:37], v[96:97], v[48:49], v[36:37] op_sel:[0,0,0] op_sel_hi:[1,0,1]
    v_pk_fma_f32 v[38:39], v[98:99], v[48:49], v[38:39] op_sel:[0,0,0] op_sel_hi:[1,0,1]
    v_pk_fma_f32 v[40:41], v[100:101], v[48:49], v[40:41] op_sel:[0,0,0] op_sel_hi:[1,0,1]
    v_pk_fma_f32 v[42:43], v[102:103], v[48:49], v[42:43] op_sel:[0,0,0] op_sel_hi:[1,0,1]
    v_cvt_pk_bf16_f32 v28, v36, v37
    v_cvt_pk_bf16_f32 v29, v38, v39
    v_cvt_pk_bf16_f32 v30, v40, v41
    v_cvt_pk_bf16_f32 v31, v42, v43
    buffer_store_dwordx4 v[28:31], v162, s[20:23], 0 offen
    s_waitcnt lgkmcnt(0)
    v_pk_add_f32 v[112:113], v[112:113], v[120:121]
    v_pk_add_f32 v[114:115], v[114:115], v[122:123]
    v_pk_add_f32 v[116:117], v[116:117], v[124:125]
    v_pk_add_f32 v[118:119], v[118:119], v[126:127]
    v_pk_fma_f32 v[44:45], v[112:113], v[48:49], v[44:45] op_sel:[0,1,0] op_sel_hi:[1,1,1]
    v_pk_fma_f32 v[46:47], v[114:115], v[48:49], v[46:47] op_sel:[0,1,0] op_sel_hi:[1,1,1]
    v_pk_fma_f32 v[52:53], v[116:117], v[48:49], v[52:53] op_sel:[0,1,0] op_sel_hi:[1,1,1]
    v_pk_fma_f32 v[54:55], v[118:119], v[48:49], v[54:55] op_sel:[0,1,0] op_sel_hi:[1,1,1]
    v_cvt_pk_bf16_f32 v32, v44, v45
    v_cvt_pk_bf16_f32 v33, v46, v47
    v_cvt_pk_bf16_f32 v34, v52, v53
    v_cvt_pk_bf16_f32 v35, v54, v55
    buffer_store_dwordx4 v[32:35], v162, s[20:23], s55 offen
L_exit_1:
    s_endpgm
L_et_62:
    s_sub_u32 s46, s46, 1
    s_cselect_b32 s71, 0x12345, s71
    s_cselect_b32 s46, 0, s46
    buffer_load_dwordx2 v[56:57], v164, s[8:11], s70 offen sc1
    buffer_load_dwordx2 v[58:59], v164, s[8:11], s70 offen offset:128 sc1
    buffer_load_dwordx2 v[60:61], v165, s[8:11], s70 offen sc1
    buffer_load_dwordx2 v[62:63], v165, s[8:11], s70 offen offset:128 sc1
    s_waitcnt vmcnt(0)
    v_max3_u32 v6, v56, v57, v58
    v_max3_u32 v6, v59, v60, v6
    v_max3_u32 v6, v61, v62, v6
    v_max_u32 v6, v63, v6
    v_cmp_eq_u32 vcc, s71, v6
    s_cbranch_vccnz L_et_62
    v_max3_u32 v7, v64, v65, v66
    v_max_u32 v7, v7, v67
    v_cmp_eq_u32 vcc, s71, v7
    s_cbranch_vccz L_sk_64
    buffer_load_dwordx4 v[64:67], v5, s[8:11], s12 offen sc1
L_sk_64:
    v_max3_u32 v7, v68, v69, v70
    v_max_u32 v7, v7, v71
    v_cmp_eq_u32 vcc, s71, v7
    s_cbranch_vccz L_sk_65
    buffer_load_dwordx4 v[68:71], v5, s[8:11], s13 offen sc1
L_sk_65:
    v_max3_u32 v7, v72, v73, v74
    v_max_u32 v7, v7, v75
    v_cmp_eq_u32 vcc, s71, v7
    s_cbranch_vccz L_sk_66
    buffer_load_dwordx4 v[72:75], v5, s[8:11], s14 offen sc1
L_sk_66:
    v_max3_u32 v7, v76, v77, v78
    v_max_u32 v7, v7, v79
    v_cmp_eq_u32 vcc, s71, v7
    s_cbranch_vccz L_sk_67
    buffer_load_dwordx4 v[76:79], v5, s[8:11], s15 offen sc1
L_sk_67:
    v_max3_u32 v7, v80, v81, v82
    v_max_u32 v7, v7, v83
    v_cmp_eq_u32 vcc, s71, v7
    s_cbranch_vccz L_sk_68
    buffer_load_dwordx4 v[80:83], v5, s[8:11], s16 offen sc1
L_sk_68:
    v_max3_u32 v7, v84, v85, v86
    v_max_u32 v7, v7, v87
    v_cmp_eq_u32 vcc, s71, v7
    s_cbranch_vccz L_sk_69
    buffer_load_dwordx4 v[84:87], v5, s[8:11], s17 offen sc1
L_sk_69:
    v_max3_u32 v7, v88, v89, v90
    v_max_u32 v7, v7, v91
    v_cmp_eq_u32 vcc, s71, v7
    s_cbranch_vccz L_sk_70
    buffer_load_dwordx4 v[88:91], v5, s[8:11], s18 offen sc1
L_sk_70:
    v_max3_u32 v7, v92, v93, v94
    v_max_u32 v7, v7, v95
    v_cmp_eq_u32 vcc, s71, v7
    s_cbranch_vccz L_sk_71
    buffer_load_dwordx4 v[92:95], v5, s[8:11], s19 offen sc1
L_sk_71:
    s_waitcnt vmcnt(0)
    s_branch L_mm2_63
L_rt_59:
    s_mov_b32 s47, 1
    s_sub_u32 s46, s46, 1
    s_cselect_b32 s71, 0x12345, s71
    s_cselect_b32 s46, 0, s46
    ds_read_b64_tr_b16 v[96:97], v161 offset:0
    ds_read_b64_tr_b16 v[98:99], v161 offset:3200
    ds_read_b64_tr_b16 v[100:101], v161 offset:32
    ds_read_b64_tr_b16 v[102:103], v161 offset:3232
    ds_read_b64_tr_b16 v[104:105], v161 offset:64
    ds_read_b64_tr_b16 v[106:107], v161 offset:3264
    ds_read_b64_tr_b16 v[108:109], v161 offset:96
    ds_read_b64_tr_b16 v[110:111], v161 offset:3296
    ds_read_b64_tr_b16 v[112:113], v161 offset:128
    ds_read_b64_tr_b16 v[114:115], v161 offset:3328
    ds_read_b64_tr_b16 v[116:117], v161 offset:25600
    ds_read_b64_tr_b16 v[118:119], v161 offset:28800
    ds_read_b64_tr_b16 v[120:121], v161 offset:25632
    ds_read_b64_tr_b16 v[122:123], v161 offset:28832
    ds_read_b64_tr_b16 v[124:125], v161 offset:25664
    ds_read_b64_tr_b16 v[126:127], v161 offset:28864
    ds_read_b64_tr_b16 v[128:129], v161 offset:25696
    ds_read_b64_tr_b16 v[130:131], v161 offset:28896
    ds_read_b64_tr_b16 v[132:133], v161 offset:25728
    ds_read_b64_tr_b16 v[134:135], v161 offset:28928
    ds_read_b64_tr_b16 v[136:137], v160 offset:0
    ds_read_b64_tr_b16 v[138:139], v160 offset:1280
    ds_read_b64_tr_b16 v[140:141], v160 offset:32
    ds_read_b64_tr_b16 v[142:143], v160 offset:1312
    ds_read_b64_tr_b16 v[144:145], v160 offset:64
    ds_read_b64_tr_b16 v[146:147], v160 offset:1344
    ds_read_b64_tr_b16 v[148:149], v160 offset:96
    ds_read_b64_tr_b16 v[150:151], v160 offset:1376
    ds_read_b64_tr_b16 v[152:153], v160 offset:128
    ds_read_b64_tr_b16 v[154:155], v160 offset:1408
    s_branch L_rl_57
L_sel_60:
    ds_read_b128 v[28:31], v167
    ds_read_b128 v[32:35], v167 offset:16
    s_waitcnt lgkmcnt(0)
    v_add_u32 v6, 0, v163
    v_cmp_eq_u32 vcc, s56, v6
    v_add_f32 v6, v36, v28
    v_cvt_pk_bf16_f32 v6, v6, v6
    v_and_b32 v6, 0xffff0000, v6
    v_cndmask_b32 v36, v36, v6, vcc
    v_add_f32 v6, v37, v29
    v_cvt_pk_bf16_f32 v6, v6, v6
    v_and_b32 v6, 0xffff0000, v6
    v_cndmask_b32 v37, v37, v6, vcc
    v_add_f32 v6, v38, v30
    v_cvt_pk_bf16_f32 v6, v6, v6
    v_and_b32 v6, 0xffff0000, v6
    v_cndmask_b32 v38, v38, v6, vcc
    v_add_f32 v6, v39, v31
    v_cvt_pk_bf16_f32 v6, v6, v6
    v_and_b32 v6, 0xffff0000, v6
    v_cndmask_b32 v39, v39, v6, vcc
    v_add_f32 v6, v40, v32
    v_cvt_pk_bf16_f32 v6, v6, v6
    v_and_b32 v6, 0xffff0000, v6
    v_cndmask_b32 v40, v40, v6, vcc
    v_add_f32 v6, v41, v33
    v_cvt_pk_bf16_f32 v6, v6, v6
    v_and_b32 v6, 0xffff0000, v6
    v_cndmask_b32 v41, v41, v6, vcc
    v_add_f32 v6, v42, v34
    v_cvt_pk_bf16_f32 v6, v6, v6
    v_and_b32 v6, 0xffff0000, v6
    v_cndmask_b32 v42, v42, v6, vcc
    v_add_f32 v6, v43, v35
    v_cvt_pk_bf16_f32 v6, v6, v6
    v_and_b32 v6, 0xffff0000, v6
    v_cndmask_b32 v43, v43, v6, vcc
    v_add_u32 v6, 4, v163
    v_cmp_eq_u32 vcc, s56, v6
    v_add_f32 v6, v44, v28
    v_cvt_pk_bf16_f32 v6, v6, v6
    v_and_b32 v6, 0xffff0000, v6
    v_cndmask_b32 v44, v44, v6, vcc
    v_add_f32 v6, v45, v29
    v_cvt_pk_bf16_f32 v6, v6, v6
    v_and_b32 v6, 0xffff0000, v6
    v_cndmask_b32 v45, v45, v6, vcc
    v_add_f32 v6, v46, v30
    v_cvt_pk_bf16_f32 v6, v6, v6
    v_and_b32 v6, 0xffff0000, v6
    v_cndmask_b32 v46, v46, v6, vcc
    v_add_f32 v6, v47, v31
    v_cvt_pk_bf16_f32 v6, v6, v6
    v_and_b32 v6, 0xffff0000, v6
    v_cndmask_b32 v47, v47, v6, vcc
    v_add_f32 v6, v52, v32
    v_cvt_pk_bf16_f32 v6, v6, v6
    v_and_b32 v6, 0xffff0000, v6
    v_cndmask_b32 v52, v52, v6, vcc
    v_add_f32 v6, v53, v33
    v_cvt_pk_bf16_f32 v6, v6, v6
    v_and_b32 v6, 0xffff0000, v6
    v_cndmask_b32 v53, v53, v6, vcc
    v_add_f32 v6, v54, v34
    v_cvt_pk_bf16_f32 v6, v6, v6
    v_and_b32 v6, 0xffff0000, v6
    v_cndmask_b32 v54, v54, v6, vcc
    v_add_f32 v6, v55, v35
    v_cvt_pk_bf16_f32 v6, v6, v6
    v_and_b32 v6, 0xffff0000, v6
    v_cndmask_b32 v55, v55, v6, vcc
    s_branch L_nosel_61
L_kr_20:
    ds_read_b32 v24, v30 offset:16
    s_waitcnt lgkmcnt(0)
    v_readfirstlane_b32 s32, v24
    s_cmp_lt_u32 s32, 4
    s_cbranch_scc1 L_kr_20
    s_branch L_loop_18
L_aw_13:
    s_waitcnt vmcnt(0)
    s_branch L_awr_14
L_rgl_15:
L_c_72:
    s_add_u32 s46, s46, 1
    s_cmp_eq_u32 s46, 7
    s_cselect_b32 s32, s34, 10240
    ds_read_b128 v[108:111], v17
    ds_read_b64_tr_b16 v[84:85], v14 offset:5120
    ds_read_b64_tr_b16 v[86:87], v15 offset:5120
    s_waitcnt lgkmcnt(11)
    v_mfma_f32_16x16x32_bf16 v[32:35], v[64:67], v[104:107], v[32:35]
    ds_read_b64_tr_b16 v[88:89], v14 offset:5152
    ds_read_b64_tr_b16 v[90:91], v15 offset:5152
    s_waitcnt lgkmcnt(11)
    v_mfma_f32_16x16x32_bf16 v[36:39], v[68:71], v[104:107], v[36:39]
    ds_read_b64_tr_b16 v[92:93], v14 offset:5184
    ds_read_b64_tr_b16 v[94:95], v15 offset:5184
    s_waitcnt lgkmcnt(11)
    v_mfma_f32_16x16x32_bf16 v[40:43], v[72:75], v[104:107], v[40:43]
    ds_read_b64_tr_b16 v[96:97], v14 offset:5216
    ds_read_b64_tr_b16 v[98:99], v15 offset:5216
    s_waitcnt lgkmcnt(11)
    v_mfma_f32_16x16x32_bf16 v[44:47], v[76:79], v[104:107], v[44:47]
    ds_read_b64_tr_b16 v[100:101], v14 offset:5248
    ds_read_b64_tr_b16 v[102:103], v15 offset:5248
    s_waitcnt lgkmcnt(11)
    v_mfma_f32_16x16x32_bf16 v[48:51], v[80:83], v[104:107], v[48:51]
    v_add_u32 v14, s32, v14
    v_add_u32 v15, s32, v15
    v_add_u32 v16, 8192, v16
    v_add_u32 v17, 8192, v17
    s_add_u32 s25, s25, 1
    s_cmp_eq_u32 s25, 10
    s_cselect_b32 s25, 0, s25
    s_lshl_b32 s32, s25, 7
    v_add_u32 v6, s32, v18
    s_waitcnt lgkmcnt(10)
    v_mfma_f32_16x16x32_bf16 v[52:55], v[112:115], v[104:107], v[52:55]
    v_mfma_f32_16x16x32_bf16 v[52:55], v[116:119], v[108:111], v[52:55]
    ds_read_b128 v[112:115], v6
    ds_read_b128 v[116:119], v6 offset:64
    s_cmp_lt_u32 s46, 10
    s_barrier
    ds_read_b128 v[104:107], v16
    ds_read_b64_tr_b16 v[64:65], v14 offset:0
    ds_read_b64_tr_b16 v[66:67], v15 offset:0
    s_waitcnt lgkmcnt(11)
    v_mfma_f32_16x16x32_bf16 v[32:35], v[84:87], v[108:111], v[32:35]
    ds_read_b64_tr_b16 v[68:69], v14 offset:32
    ds_read_b64_tr_b16 v[70:71], v15 offset:32
    s_waitcnt lgkmcnt(11)
    v_mfma_f32_16x16x32_bf16 v[36:39], v[88:91], v[108:111], v[36:39]
    ds_read_b64_tr_b16 v[72:73], v14 offset:64
    ds_read_b64_tr_b16 v[74:75], v15 offset:64
    s_waitcnt lgkmcnt(11)
    v_mfma_f32_16x16x32_bf16 v[40:43], v[92:95], v[108:111], v[40:43]
    ds_read_b64_tr_b16 v[76:77], v14 offset:96
    ds_read_b64_tr_b16 v[78:79], v15 offset:96
    s_waitcnt lgkmcnt(11)
    v_mfma_f32_16x16x32_bf16 v[44:47], v[96:99], v[108:111], v[44:47]
    ds_read_b64_tr_b16 v[80:81], v14 offset:128
    ds_read_b64_tr_b16 v[82:83], v15 offset:128
    s_waitcnt lgkmcnt(11)
    v_mfma_f32_16x16x32_bf16 v[48:51], v[100:103], v[108:111], v[48:51]
    s_cbranch_scc1 L_c_72
    v_add_u32 v8, s50, v2
    v_lshlrev_b32 v6, 2, v8
    v_lshl_or_b32 v6, v3, 28, v6
    v_sub_u32 v8, 2047, v8
    s_mov_b32 s33, 397312
    s_mov_b32 s34, 405504
    buffer_store_dword v52, v6, s[8:11], s33 offen sc1
    buffer_store_dword v53, v6, s[8:11], s34 offen sc1
    v_ashrrev_i32 v7, 31, v52
    v_or_b32 v7, 0x80000000, v7
    v_xor_b32 v7, v7, v52
    v_and_b32 v7, 0xfffff800, v7
    v_or_b32 v7, v7, v8
    s_mov_b32 s34, 393728
    s_nop 1
    v_max_u32_dpp v7, v7, v7 row_ror:8 row_mask:0xf bank_mask:0xf
    s_nop 1
    v_max_u32_dpp v7, v7, v7 row_ror:4 row_mask:0xf bank_mask:0xf
    s_nop 1
    v_max_u32_dpp v7, v7, v7 row_ror:2 row_mask:0xf bank_mask:0xf
    s_nop 1
    v_max_u32_dpp v7, v7, v7 row_ror:1 row_mask:0xf bank_mask:0xf
    s_lshr_b32 s33, s50, 2
    s_add_u32 s33, s33, s34
    v_lshlrev_b32 v6, 24, v1
    buffer_store_dword v7, v6, s[8:11], s33 offen sc1
    s_mul_i32 s32, s50, 20
    s_add_u32 s32, s32, 425984
    v_cmp_gt_u32 vcc, 20, v1
    v_mov_b32 v7, 0x40000000
    s_nop 0
    v_cndmask_b32 v6, v7, v5, vcc
    buffer_store_dwordx4 v[56:59], v6, s[8:11], s32 offen sc1
    s_lshl_b32 s32, s30, 7
    s_add_u32 s33, s32, 475136
    buffer_store_dword v56, v24, s[8:11], s33 offen sc1
    s_add_u32 s33, s32, 483328
    buffer_store_dword v56, v24, s[8:11], s33 offen sc1
    s_branch L_rgr_16
L_fb_21:
    v_lshlrev_b32 v21, 3, v2
    v_cndmask_b32 v12, v12, 0, s[44:45]
    v_cndmask_b32 v14, v14, 0, s[44:45]
    v_mov_b32 v30, 0xff800000
    v_mov_b32 v31, 0xff800000
    s_mov_b32 s32, 0
L_p1_73:
    buffer_load_dwordx4 v[128:131], v5, s[8:11], s32 offen sc1
    buffer_load_dwordx2 v[132:133], v21, s[8:11], s32 offen offset:1024 sc1
    s_waitcnt vmcnt(0)
    v_mfma_f32_32x32x8_bf16 v[32:47], v[132:133], v[12:13], 0
    v_mfma_f32_32x32x16_bf16 v[32:47], v[128:131], v[8:11], v[32:47]
    v_mfma_f32_32x32x8_bf16 v[48:63], v[132:133], v[14:15], 0
    v_mfma_f32_32x32x16_bf16 v[48:63], v[128:131], v[16:19], v[48:63]
    s_nop 15
    v_max3_f32 v30, v32, v33, v30
    v_max3_f32 v31, v48, v49, v31
    v_max3_f32 v30, v34, v35, v30
    v_max3_f32 v31, v50, v51, v31
    v_max3_f32 v30, v36, v37, v30
    v_max3_f32 v31, v52, v53, v31
    v_max3_f32 v30, v38, v39, v30
    v_max3_f32 v31, v54, v55, v31
    v_max3_f32 v30, v40, v41, v30
    v_max3_f32 v31, v56, v57, v31
    v_max3_f32 v30, v42, v43, v30
    v_max3_f32 v31, v58, v59, v31
    v_max3_f32 v30, v44, v45, v30
    v_max3_f32 v31, v60, v61, v31
    v_max3_f32 v30, v46, v47, v30
    v_max3_f32 v31, v62, v63, v31
    s_add_u32 s32, s32, 2592
    s_cmp_lt_u32 s32, 165888
    s_cbranch_scc1 L_p1_73
    v_mov_b32 v28, v30
    v_mov_b32 v29, v31
    s_nop 1
    v_permlane32_swap_b32 v30, v28
    v_permlane32_swap_b32 v31, v29
    s_nop 1
    v_max_f32 v30, v30, v28
    v_max_f32 v31, v31, v29
    v_mov_b32 v96, 0
    v_mov_b32 v97, 0
    v_mov_b32 v98, 0
    v_mov_b32 v99, 0
    v_mov_b32 v100, 0
    v_mov_b32 v101, 0
    v_mov_b32 v102, 0
    v_mov_b32 v103, 0
    v_mov_b32 v104, 0
    v_mov_b32 v105, 0
    v_mov_b32 v106, 0
    v_mov_b32 v107, 0
    v_mov_b32 v108, 0
    v_mov_b32 v109, 0
    v_mov_b32 v110, 0
    v_mov_b32 v111, 0
    v_mov_b32 v112, 0
    v_mov_b32 v113, 0
    v_mov_b32 v114, 0
    v_mov_b32 v115, 0
    v_mov_b32 v116, 0
    v_mov_b32 v117, 0
    v_mov_b32 v118, 0
    v_mov_b32 v119, 0
    v_mov_b32 v120, 0
    v_mov_b32 v121, 0
    v_mov_b32 v122, 0
    v_mov_b32 v123, 0
    v_mov_b32 v124, 0
    v_mov_b32 v125, 0
    v_mov_b32 v126, 0
    v_mov_b32 v127, 0
    s_mov_b32 s32, 0
L_p2_74:
    buffer_load_dwordx4 v[128:131], v5, s[8:11], s32 offen sc1
    buffer_load_dwordx2 v[132:133], v21, s[8:11], s32 offen offset:1024 sc1
    s_add_u32 s32, s32, 2592
    s_cmp_lt_u32 s32, 165888
    s_cselect_b32 s33, s32, 0
    buffer_load_dwordx4 v[144:147], v23, s[8:11], s33 offen offset:1280 sc1
    buffer_load_dwordx4 v[148:151], v23, s[8:11], s33 offen offset:1936 sc1
    s_waitcnt vmcnt(0)
    v_mfma_f32_32x32x8_bf16 v[32:47], v[132:133], v[12:13], 0
    v_mfma_f32_32x32x16_bf16 v[32:47], v[128:131], v[8:11], v[32:47]
    v_mfma_f32_32x32x8_bf16 v[48:63], v[132:133], v[14:15], 0
    v_mfma_f32_32x32x16_bf16 v[48:63], v[128:131], v[16:19], v[48:63]
    s_nop 15
    v_sub_f32 v32, v32, v30
    v_sub_f32 v33, v33, v30
    v_sub_f32 v34, v34, v30
    v_sub_f32 v35, v35, v30
    v_sub_f32 v36, v36, v30
    v_sub_f32 v37, v37, v30
    v_sub_f32 v38, v38, v30
    v_sub_f32 v39, v39, v30
    v_sub_f32 v40, v40, v30
    v_sub_f32 v41, v41, v30
    v_sub_f32 v42, v42, v30
    v_sub_f32 v43, v43, v30
    v_sub_f32 v44, v44, v30
    v_sub_f32 v45, v45, v30
    v_sub_f32 v46, v46, v30
    v_sub_f32 v47, v47, v30
    v_sub_f32 v48, v48, v31
    v_sub_f32 v49, v49, v31
    v_sub_f32 v50, v50, v31
    v_sub_f32 v51, v51, v31
    v_sub_f32 v52, v52, v31
    v_sub_f32 v53, v53, v31
    v_sub_f32 v54, v54, v31
    v_sub_f32 v55, v55, v31
    v_sub_f32 v56, v56, v31
    v_sub_f32 v57, v57, v31
    v_sub_f32 v58, v58, v31
    v_sub_f32 v59, v59, v31
    v_sub_f32 v60, v60, v31
    v_sub_f32 v61, v61, v31
    v_sub_f32 v62, v62, v31
    v_sub_f32 v63, v63, v31
    v_exp_f32 v32, v32
    v_exp_f32 v33, v33
    v_exp_f32 v34, v34
    v_exp_f32 v35, v35
    v_exp_f32 v36, v36
    v_exp_f32 v37, v37
    v_exp_f32 v38, v38
    v_exp_f32 v39, v39
    v_exp_f32 v40, v40
    v_exp_f32 v41, v41
    v_exp_f32 v42, v42
    v_exp_f32 v43, v43
    v_exp_f32 v44, v44
    v_exp_f32 v45, v45
    v_exp_f32 v46, v46
    v_exp_f32 v47, v47
    v_exp_f32 v48, v48
    v_exp_f32 v49, v49
    v_exp_f32 v50, v50
    v_exp_f32 v51, v51
    v_exp_f32 v52, v52
    v_exp_f32 v53, v53
    v_exp_f32 v54, v54
    v_exp_f32 v55, v55
    v_exp_f32 v56, v56
    v_exp_f32 v57, v57
    v_exp_f32 v58, v58
    v_exp_f32 v59, v59
    v_exp_f32 v60, v60
    v_exp_f32 v61, v61
    v_exp_f32 v62, v62
    v_exp_f32 v63, v63
    s_nop 2
    v_smfmac_f32_32x32x32_bf16 v[96:111], v[144:147], v[32:39], v4
    v_smfmac_f32_32x32x32_bf16 v[112:127], v[144:147], v[48:55], v4
    v_smfmac_f32_32x32x32_bf16 v[96:111], v[148:151], v[40:47], v4
    v_smfmac_f32_32x32x32_bf16 v[112:127], v[148:151], v[56:63], v4
    s_cmp_lt_u32 s32, 165888
    s_cbranch_scc1 L_p2_74
    s_nop 15
    v_rcp_f32 v28, v104
    s_nop 0
    v_mov_b32 v29, v28
    s_nop 1
    v_permlane32_swap_b32 v28, v29
    s_nop 1
    s_branch L_norm_22
L_HELP2:
    s_load_dwordx2 s[38:39], s[0:1], 32
    s_load_dwordx4 s[40:43], s[0:1], 56
    s_load_dwordx2 s[44:45], s[0:1], 72
    s_mov_b32 s8, s50
    s_and_b32 s9, s51, 0xffff
    s_mov_b32 s76, s48
    s_and_b32 s77, s49, 0xffff
    v_lshlrev_b32 v174, 24, v1
    buffer_load_dword v29, v174, s[76:79], 0 offen offset:128 sc1
    s_mov_b32 s4, s36
    s_mov_b32 s5, s37
    s_lshl_b32 s32, s26, 10
    s_mov_b32 m0, s32
    s_add_u32 s53, s32, s24
    s_barrier
    s_barrier
    s_mul_i32 s64, s26, 5120
    s_add_u32 s64, s64, s54
    s_mul_i32 s32, s73, 51200
    s_add_u32 s64, s64, s32
    s_mov_b32 s69, 409600
    s_mul_i32 s65, s26, 640
    s_waitcnt lgkmcnt(0)
    s_mov_b32 s60, s38
    s_and_b32 s61, s39, 0xffff
    s_mov_b32 s62, 0xc8000
    s_mov_b32 s63, 0x00020000
    s_waitcnt vmcnt(0)
    v_readfirstlane_b32 s32, v29
    s_or_b32 s32, s32, s26
    s_cmp_lg_u32 s32, 0
    s_cbranch_scc1 L_g1_97
    v_lshlrev_b32 v29, 24, v1
    s_mov_b32 s33, 100000
L_aw_99:
    buffer_load_dword v28, v29, s[76:79], 0 offen offset:128 sc1
    s_waitcnt vmcnt(0)
    v_readfirstlane_b32 s32, v28
    s_sub_u32 s33, s33, 1
    s_cbranch_scc1 L_awd_100
    s_cmp_lg_u32 s32, 0
    s_cbranch_scc1 L_awd_100
    s_sleep 1
    s_branch L_aw_99
L_awd_100:
L_g1_97:
    s_barrier
    s_add_u32 s34, m0, 32768
L_dma_101:
    buffer_load_dwordx4 v5, s[8:11], s53 offen sc1 lds
    s_add_u32 m0, m0, 4096
    s_add_u32 s53, s53, 4096
    s_cmp_ge_u32 s53, 165888
    s_cselect_b32 s32, 165888, 0
    s_sub_u32 s53, s53, s32
    s_cmp_lt_u32 m0, s34
    s_cbranch_scc1 L_dma_101
    s_waitcnt vmcnt(2)
    s_barrier
    s_lshl_b32 s32, s26, 3
    s_or_b32 s32, s32, s3
    s_mov_b32 s35, 1
    s_cmp_lg_u32 s32, 2
    s_cbranch_scc1 L_b3_103
    s_atomic_add s35, s[48:49], 0x4 glc
L_b3_103:
    s_mov_b64 exec, 1
    ds_write_b64 v173, v[6:7]
    ds_write_b64 v173, v[6:7] offset:8
    ds_write_b32 v173, v6 offset:16
    s_mov_b64 exec, -1
    s_add_u32 s34, m0, 126976
L_dma_105:
    buffer_load_dwordx4 v5, s[8:11], s53 offen sc1 lds
    s_add_u32 m0, m0, 4096
    s_add_u32 s53, s53, 4096
    s_cmp_ge_u32 s53, 165888
    s_cselect_b32 s32, 165888, 0
    s_sub_u32 s53, s53, s32
    s_cmp_lt_u32 m0, s34
    s_cbranch_scc1 L_dma_105
    s_cmp_eq_u32 s26, 3
    s_cselect_b32 s32, 0x3fffffff, -1
    s_cselect_b32 s33, 0, -1
    s_mov_b64 exec, s[32:33]
    buffer_load_dwordx4 v5, s[8:11], s53 offen sc1 lds
    s_mov_b64 exec, -1
    s_waitcnt vmcnt(29) lgkmcnt(0)
    s_cmp_lg_u32 s35, 31
    s_cbranch_scc1 L_b4_104
    s_atomic_add s35, s[48:49], 0x84
L_b4_104:
    s_barrier
    buffer_store_dwordx4 v[176:179], v169, s[8:11], s74 offen sc1
    buffer_store_dwordx2 v[176:177], v170, s[8:11], s75 offen sc1
    buffer_store_dwordx4 v[176:179], v169, s[8:11], s58 offen sc1
    buffer_store_dwordx2 v[176:177], v170, s[8:11], s59 offen sc1
    buffer_load_dword v28, v174, s[76:79], 0 offen offset:132 sc1
    s_waitcnt vmcnt(0)
    s_mov_b64 exec, 1
    ds_add_u32 v173, v175 offset:16
    s_mov_b64 exec, -1
    v_readfirstlane_b32 s32, v28
    s_cmp_lg_u32 s32, 0
    s_cbranch_scc1 L_b2_102
    v_lshlrev_b32 v29, 24, v1
    s_mov_b32 s33, 100000
L_aw_106:
    buffer_load_dword v28, v29, s[76:79], 0 offen offset:132 sc1
    s_waitcnt vmcnt(0)
    v_readfirstlane_b32 s32, v28
    s_sub_u32 s33, s33, 1
    s_cbranch_scc1 L_awd_107
    s_cmp_lg_u32 s32, 0
    s_cbranch_scc1 L_awd_107
    s_sleep 8
    s_branch L_aw_106
L_awd_107:
L_b2_102:
    s_mov_b32 s32, 393728
    buffer_load_dwordx2 v[6:7], v10, s[8:11], s32 offen sc1
    s_lshl_b32 s35, s30, 7
    s_add_u32 s35, s35, 475136
    buffer_atomic_add v175, v174, s[8:11], s35 offen sc1
    s_mul_i32 s47, s30, 6
    s_add_u32 s47, s47, s3
    s_sub_u32 s47, s47, 2
    s_cmp_lt_u32 s3, 2
    s_cbranch_scc1 L_w1_108
    s_cmp_ge_u32 s26, 2
    s_cselect_b32 s16, s42, s40
    s_cselect_b32 s17, s43, s41
    s_and_b32 s17, s17, 0xffff
    s_mov_b32 s18, 1966080
    s_mov_b32 s20, s44
    s_and_b32 s21, s45, 0xffff
    s_mov_b32 s22, 0x1e0000
    s_mov_b32 s23, 0x00020000
    s_and_b32 s46, s26, 1
    s_mul_i32 s32, s46, 983040
    s_lshl_b32 s33, s47, 4
    s_add_u32 s32, s32, s33
    buffer_load_dwordx4 v[32:35], v11, s[16:19], s32 offen
    s_add_u32 s32, s32, 196608
    buffer_load_dwordx4 v[36:39], v11, s[16:19], s32 offen
    s_add_u32 s32, s32, 196608
    buffer_load_dwordx4 v[40:43], v11, s[16:19], s32 offen
    s_add_u32 s32, s32, 196608
    buffer_load_dwordx4 v[44:47], v11, s[16:19], s32 offen
    s_add_u32 s32, s32, 196608
    buffer_load_dwordx4 v[48:51], v11, s[16:19], s32 offen
    s_waitcnt vmcnt(5)
    s_setprio 2
    v_max_u32 v6, v6, v7
    s_nop 1
    v_max_u32_dpp v6, v6, v6 row_ror:8 row_mask:0xf bank_mask:0xf
    s_nop 1
    v_max_u32_dpp v6, v6, v6 row_ror:4 row_mask:0xf bank_mask:0xf
    s_nop 1
    v_max_u32_dpp v6, v6, v6 row_ror:2 row_mask:0xf bank_mask:0xf
    s_nop 1
    v_max_u32_dpp v6, v6, v6 row_ror:1 row_mask:0xf bank_mask:0xf
    s_nop 1
    v_readlane_b32 s56, v6, 0
    v_readlane_b32 s57, v6, 16
    v_readlane_b32 s58, v6, 32
    v_readlane_b32 s59, v6, 48
    s_max_u32 s56, s56, s57
    s_max_u32 s58, s58, s59
    s_max_u32 s56, s56, s58
    s_setprio 0
    s_and_b32 s56, s56, 2047
    s_sub_u32 s25, 2047, s56
    s_mul_i32 s32, s25, 1280
    s_mul_i32 s33, s46, 640
    s_add_u32 s32, s32, s33
    buffer_load_ushort v72, v9, s[12:15], s32 offen offset:0
    buffer_load_ushort v73, v9, s[12:15], s32 offen offset:128
    buffer_load_ushort v74, v9, s[12:15], s32 offen offset:256
    buffer_load_ushort v75, v9, s[12:15], s32 offen offset:384
    buffer_load_ushort v76, v9, s[12:15], s32 offen offset:512
    s_mul_i32 s32, s47, 10240
    s_mul_i32 s33, s26, 320
    s_add_u32 s32, s32, s33
    buffer_load_dwordx2 v[56:57], v4, s[20:23], s32 offen offset:0
    buffer_load_dwordx2 v[58:59], v4, s[20:23], s32 offen offset:1280
    buffer_load_dwordx2 v[60:61], v4, s[20:23], s32 offen offset:2560
    s_add_u32 s32, s32, 3840
    buffer_load_dwordx2 v[62:63], v4, s[20:23], s32 offen offset:0
    buffer_load_dwordx2 v[64:65], v4, s[20:23], s32 offen offset:1280
    buffer_load_dwordx2 v[66:67], v4, s[20:23], s32 offen offset:2560
    s_add_u32 s32, s32, 3840
    buffer_load_dwordx2 v[68:69], v4, s[20:23], s32 offen offset:0
    buffer_load_dwordx2 v[70:71], v4, s[20:23], s32 offen offset:1280
    s_waitcnt vmcnt(8)
    s_setprio 2
    v_lshlrev_b32 v77, 16, v72
    v_dot2c_f32_bf16 v12, v32, v72
    v_dot2c_f32_bf16 v13, v32, v77
    v_dot2c_f32_bf16 v14, v33, v72
    v_dot2c_f32_bf16 v15, v33, v77
    v_dot2c_f32_bf16 v16, v34, v72
    v_dot2c_f32_bf16 v17, v34, v77
    v_dot2c_f32_bf16 v18, v35, v72
    v_dot2c_f32_bf16 v19, v35, v77
    v_lshlrev_b32 v77, 16, v73
    v_dot2c_f32_bf16 v12, v36, v73
    v_dot2c_f32_bf16 v13, v36, v77
    v_dot2c_f32_bf16 v14, v37, v73
    v_dot2c_f32_bf16 v15, v37, v77
    v_dot2c_f32_bf16 v16, v38, v73
    v_dot2c_f32_bf16 v17, v38, v77
    v_dot2c_f32_bf16 v18, v39, v73
    v_dot2c_f32_bf16 v19, v39, v77
    v_lshlrev_b32 v77, 16, v74
    v_dot2c_f32_bf16 v12, v40, v74
    v_dot2c_f32_bf16 v13, v40, v77
    v_dot2c_f32_bf16 v14, v41, v74
    v_dot2c_f32_bf16 v15, v41, v77
    v_dot2c_f32_bf16 v16, v42, v74
    v_dot2c_f32_bf16 v17, v42, v77
    v_dot2c_f32_bf16 v18, v43, v74
    v_dot2c_f32_bf16 v19, v43, v77
    v_lshlrev_b32 v77, 16, v75
    v_dot2c_f32_bf16 v12, v44, v75
    v_dot2c_f32_bf16 v13, v44, v77
    v_dot2c_f32_bf16 v14, v45, v75
    v_dot2c_f32_bf16 v15, v45, v77
    v_dot2c_f32_bf16 v16, v46, v75
    v_dot2c_f32_bf16 v17, v46, v77
    v_dot2c_f32_bf16 v18, v47, v75
    v_dot2c_f32_bf16 v19, v47, v77
    v_lshlrev_b32 v77, 16, v76
    v_dot2c_f32_bf16 v12, v48, v76
    v_dot2c_f32_bf16 v13, v48, v77
    v_dot2c_f32_bf16 v14, v49, v76
    v_dot2c_f32_bf16 v15, v49, v77
    v_dot2c_f32_bf16 v16, v50, v76
    v_dot2c_f32_bf16 v17, v50, v77
    v_dot2c_f32_bf16 v18, v51, v76
    v_dot2c_f32_bf16 v19, v51, v77
    s_nop 3
    v_permlane32_swap_b32 v12, v16
    v_permlane32_swap_b32 v13, v17
    v_permlane32_swap_b32 v14, v18
    v_permlane32_swap_b32 v15, v19
    s_nop 1
    v_add_f32 v12, v12, v16
    v_add_f32 v13, v13, v17
    v_add_f32 v14, v14, v18
    v_add_f32 v15, v15, v19
    s_nop 1
    v_permlane16_swap_b32 v12, v14
    v_permlane16_swap_b32 v13, v15
    s_nop 1
    v_add_f32 v12, v12, v14
    v_add_f32 v13, v13, v15
    s_nop 1
    v_add_f32_dpp v12, v12, v12 row_ror:8 row_mask:0xf bank_mask:0xf
    v_add_f32_dpp v13, v13, v13 row_ror:8 row_mask:0xf bank_mask:0xf
    s_nop 1
    v_add_f32_dpp v12, v12, v12 row_ror:4 row_mask:0xf bank_mask:0xf
    v_add_f32_dpp v13, v13, v13 row_ror:4 row_mask:0xf bank_mask:0xf
    s_nop 1
    v_add_f32_dpp v12, v12, v12 row_ror:2 row_mask:0xf bank_mask:0xf
    v_add_f32_dpp v13, v13, v13 row_ror:2 row_mask:0xf bank_mask:0xf
    s_nop 1
    v_add_f32_dpp v12, v12, v12 row_ror:1 row_mask:0xf bank_mask:0xf
    v_add_f32_dpp v13, v13, v13 row_ror:1 row_mask:0xf bank_mask:0xf
    s_mov_b32 s32, 0x00010001
    s_mov_b32 s33, 0x00010001
    s_mov_b64 exec, s[32:33]
    ds_write_b64 v25, v[12:13]
    s_mov_b64 exec, -1
    s_setprio 0
    s_waitcnt lgkmcnt(0)
    s_mov_b64 exec, 1
    ds_add_u32 v173, v175
    s_mov_b64 exec, -1
L_pw_111:
    ds_read_b32 v171, v173 offset:4
    s_waitcnt lgkmcnt(0)
    v_readfirstlane_b32 s32, v171
    s_sleep 20
    s_add_u32 s32, s32, 0x7e7e7e7e
    s_andn2_b32 s32, 0x80808080, s32
    s_cbranch_scc1 L_pw_111
    s_add_u32 s34, s65, 51200
    s_mov_b64 exec, s[66:67]
L_wl_110:
    s_mov_b32 m0, s65
    s_add_u32 s32, s64, s69
    buffer_load_dwordx4 v172, s[60:63], s32 offen lds
    s_add_u32 s65, s65, 2560
    s_add_u32 s64, s64, 20480
    s_cmp_ge_u32 s64, 409600
    s_cselect_b32 s32, 409600, 0
    s_sub_u32 s64, s64, s32
    s_cmp_lt_u32 s65, s34
    s_cbranch_scc1 L_wl_110
    s_mov_b64 exec, -1
L_lw_112:
    ds_read_b32 v171, v173 offset:0
    s_waitcnt lgkmcnt(0)
    v_readfirstlane_b32 s32, v171
    s_sleep 2
    s_cmp_lt_u32 s32, 4
    s_cbranch_scc1 L_lw_112
    s_setprio 2
    ds_read2_b32 v[12:13], v8 offset0:0 offset1:8
    ds_read2_b32 v[14:15], v8 offset0:16 offset1:24
    s_waitcnt lgkmcnt(0)
    v_add_f32 v12, v12, v13
    v_add_f32 v14, v14, v15
    v_cvt_pk_bf16_f32 v12, v12, v12
    v_and_b32 v12, 0xffff0000, v12
    v_mul_f32 v17, 0xbfb8aa3b, v12
    v_exp_f32 v17, v17
    s_nop 0
    v_add_f32 v17, 1.0, v17
    v_rcp_f32 v16, v17
    s_nop 0
    v_mul_f32 v12, v12, v16
    v_cvt_pk_bf16_f32 v12, v12, v12
    v_and_b32 v12, 0xffff0000, v12
    v_cvt_pk_bf16_f32 v14, v14, v14
    v_and_b32 v14, 0xffff0000, v14
    v_mul_f32 v12, v12, v14
    v_cvt_pk_bf16_f32 v12, v12, v12
    v_and_b32 v12, 0xffff0000, v12
    s_nop 0
    v_readlane_b32 s13, v12, 0
    v_readlane_b32 s15, v12, 1
    v_readlane_b32 s17, v12, 2
    v_readlane_b32 s19, v12, 3
    v_readlane_b32 s37, v12, 4
    v_readlane_b32 s39, v12, 5
    v_readlane_b32 s41, v12, 6
    v_readlane_b32 s43, v12, 7
    s_lshr_b32 s12, s13, 16
    s_lshr_b32 s14, s15, 16
    s_lshr_b32 s16, s17, 16
    s_lshr_b32 s18, s19, 16
    s_lshr_b32 s36, s37, 16
    s_lshr_b32 s38, s39, 16
    s_lshr_b32 s40, s41, 16
    s_lshr_b32 s42, s43, 16
    s_waitcnt vmcnt(20)
    v_dot2c_f32_bf16 v20, s12, v56
    v_dot2c_f32_bf16 v21, s13, v56
    v_dot2c_f32_bf16 v22, s12, v57
    v_dot2c_f32_bf16 v23, s13, v57
    v_dot2c_f32_bf16 v20, s14, v58
    v_dot2c_f32_bf16 v21, s15, v58
    v_dot2c_f32_bf16 v22, s14, v59
    v_dot2c_f32_bf16 v23, s15, v59
    v_dot2c_f32_bf16 v20, s16, v60
    v_dot2c_f32_bf16 v21, s17, v60
    v_dot2c_f32_bf16 v22, s16, v61
    v_dot2c_f32_bf16 v23, s17, v61
    v_dot2c_f32_bf16 v20, s18, v62
    v_dot2c_f32_bf16 v21, s19, v62
    v_dot2c_f32_bf16 v22, s18, v63
    v_dot2c_f32_bf16 v23, s19, v63
    v_dot2c_f32_bf16 v20, s36, v64
    v_dot2c_f32_bf16 v21, s37, v64
    v_dot2c_f32_bf16 v22, s36, v65
    v_dot2c_f32_bf16 v23, s37, v65
    v_dot2c_f32_bf16 v20, s38, v66
    v_dot2c_f32_bf16 v21, s39, v66
    v_dot2c_f32_bf16 v22, s38, v67
    v_dot2c_f32_bf16 v23, s39, v67
    v_dot2c_f32_bf16 v20, s40, v68
    v_dot2c_f32_bf16 v21, s41, v68
    v_dot2c_f32_bf16 v22, s40, v69
    v_dot2c_f32_bf16 v23, s41, v69
    v_dot2c_f32_bf16 v20, s42, v70
    v_dot2c_f32_bf16 v21, s43, v70
    v_dot2c_f32_bf16 v22, s42, v71
    v_dot2c_f32_bf16 v23, s43, v71
    s_and_b32 s47, s47, 15
    s_mul_i32 s32, s47, 2560
    s_mul_i32 s33, s26, 640
    s_add_u32 s32, s32, s33
    s_add_u32 s32, s32, 425984
    s_setprio 0
    s_nop 2
    buffer_atomic_add_f32 v20, v26, s[8:11], s32 offen offset:0
    buffer_atomic_add_f32 v21, v26, s[8:11], s32 offen offset:4
    buffer_atomic_add_f32 v22, v26, s[8:11], s32 offen offset:8
    buffer_atomic_add_f32 v23, v26, s[8:11], s32 offen offset:12
    s_lshl_b32 s32, s47, 7
    s_add_u32 s32, s32, 483328
    s_waitcnt vmcnt(0)
    buffer_atomic_add v175, v174, s[8:11], s32 offen sc1
    s_branch L_w2_109
L_w1_108:
    s_waitcnt vmcnt(0)
    s_setprio 2
    v_max_u32 v6, v6, v7
    s_nop 1
    v_max_u32_dpp v6, v6, v6 row_ror:8 row_mask:0xf bank_mask:0xf
    s_nop 1
    v_max_u32_dpp v6, v6, v6 row_ror:4 row_mask:0xf bank_mask:0xf
    s_nop 1
    v_max_u32_dpp v6, v6, v6 row_ror:2 row_mask:0xf bank_mask:0xf
    s_nop 1
    v_max_u32_dpp v6, v6, v6 row_ror:1 row_mask:0xf bank_mask:0xf
    s_nop 1
    v_readlane_b32 s56, v6, 0
    v_readlane_b32 s57, v6, 16
    v_readlane_b32 s58, v6, 32
    v_readlane_b32 s59, v6, 48
    s_max_u32 s56, s56, s57
    s_max_u32 s58, s58, s59
    s_max_u32 s56, s56, s58
    s_setprio 0
    s_and_b32 s56, s56, 2047
    s_sub_u32 s25, 2047, s56
L_pw_114:
    ds_read_b32 v171, v173 offset:4
    s_waitcnt lgkmcnt(0)
    v_readfirstlane_b32 s32, v171
    s_sleep 20
    s_add_u32 s32, s32, 0x7e7e7e7e
    s_andn2_b32 s32, 0x80808080, s32
    s_cbranch_scc1 L_pw_114
    s_add_u32 s34, s65, 51200
    s_mov_b64 exec, s[66:67]
L_wl_113:
    s_mov_b32 m0, s65
    s_add_u32 s32, s64, s69
    buffer_load_dwordx4 v172, s[60:63], s32 offen lds
    s_add_u32 s65, s65, 2560
    s_add_u32 s64, s64, 20480
    s_cmp_ge_u32 s64, 409600
    s_cselect_b32 s32, 409600, 0
    s_sub_u32 s64, s64, s32
    s_cmp_lt_u32 s65, s34
    s_cbranch_scc1 L_wl_113
    s_mov_b64 exec, -1
    s_waitcnt vmcnt(0)
L_w2_109:
    s_mov_b64 exec, 1
    ds_add_u32 v173, v175 offset:8
    s_mov_b64 exec, -1
    s_lshl_b32 s33, s30, 2
    s_add_u32 s33, s33, s27
    s_mul_i32 s68, s33, 20480
    s_add_u32 s68, s68, 1048576
    s_lshl_b32 s33, s28, 11
    s_add_u32 s70, s68, s33
    s_add_u32 s70, s70, 16384
    s_lshl_b32 s33, s28, 13
    s_add_u32 s68, s68, s33
    s_add_u32 s32, s73, 0
    s_and_b32 s32, s32, 7
    s_lshl_b32 s12, s32, 10
    s_add_u32 s12, s12, s68
    s_add_u32 s32, s73, 1
    s_and_b32 s32, s32, 7
    s_lshl_b32 s13, s32, 10
    s_add_u32 s13, s13, s68
    s_add_u32 s32, s73, 2
    s_and_b32 s32, s32, 7
    s_lshl_b32 s14, s32, 10
    s_add_u32 s14, s14, s68
    s_add_u32 s32, s73, 3
    s_and_b32 s32, s32, 7
    s_lshl_b32 s15, s32, 10
    s_add_u32 s15, s15, s68
    s_add_u32 s32, s73, 4
    s_and_b32 s32, s32, 7
    s_lshl_b32 s16, s32, 10
    s_add_u32 s16, s16, s68
    s_add_u32 s32, s73, 5
    s_and_b32 s32, s32, 7
    s_lshl_b32 s17, s32, 10
    s_add_u32 s17, s17, s68
    s_add_u32 s32, s73, 6
    s_and_b32 s32, s32, 7
    s_lshl_b32 s18, s32, 10
    s_add_u32 s18, s18, s68
    s_add_u32 s32, s73, 7
    s_and_b32 s32, s32, 7
    s_lshl_b32 s19, s32, 10
    s_add_u32 s19, s19, s68
    s_movk_i32 s55, 5120
    s_mov_b32 s22, 2621440
    s_mov_b32 s23, 0x00020000
L_lw_115:
    ds_read_b32 v171, v173 offset:8
    s_waitcnt lgkmcnt(0)
    v_readfirstlane_b32 s32, v171
    s_sleep 2
    s_cmp_lt_u32 s32, 4
    s_cbranch_scc1 L_lw_115
    s_branch L_oproj_3
L_h2_54:
    v_mov_b32 v171, s25
    s_mov_b64 exec, 1
    ds_write_b32 v173, v171 offset:12
    s_mov_b64 exec, -1
    s_mov_b32 s69, 0
L_pw_122:
    ds_read_b32 v171, v173 offset:4
    s_waitcnt lgkmcnt(0)
    v_readfirstlane_b32 s32, v171
    s_sleep 20
    s_add_u32 s32, s32, 0x7d7d7d7d
    s_andn2_b32 s32, 0x80808080, s32
    s_cbranch_scc1 L_pw_122
    s_add_u32 s34, s65, 51200
    s_mov_b64 exec, s[66:67]
L_wl_121:
    s_mov_b32 m0, s65
    s_add_u32 s32, s64, s69
    buffer_load_dwordx4 v172, s[60:63], s32 offen lds
    s_add_u32 s65, s65, 2560
    s_add_u32 s64, s64, 20480
    s_cmp_ge_u32 s64, 409600
    s_cselect_b32 s32, 409600, 0
    s_sub_u32 s64, s64, s32
    s_cmp_lt_u32 s65, s34
    s_cbranch_scc1 L_wl_121
    s_mov_b64 exec, -1
    s_waitcnt vmcnt(20)
    s_setprio 2
    v_cvt_pk_bf16_f32 v48, v48, v48
    v_and_b32 v48, 0xffff0000, v48
    v_mul_f32 v50, 0xbfb8aa3b, v48
    v_exp_f32 v50, v50
    s_nop 0
    v_add_f32 v50, 1.0, v50
    v_rcp_f32 v48, v50
    s_nop 0
    v_cvt_pk_bf16_f32 v48, v48, v48
    v_and_b32 v48, 0xffff0000, v48
    v_cvt_pk_bf16_f32 v49, v49, v49
    v_and_b32 v49, 0xffff0000, v49
    v_mul_f32 v50, 0xbfb8aa3b, v49
    v_exp_f32 v50, v50
    s_nop 0
    v_add_f32 v50, 1.0, v50
    v_rcp_f32 v49, v50
    s_nop 0
    v_cvt_pk_bf16_f32 v49, v49, v49
    v_and_b32 v49, 0xffff0000, v49
    v_sub_f32 v50, 1.0, v48
    v_cvt_pk_bf16_f32 v50, v50, v50
    v_and_b32 v50, 0xffff0000, v50
    v_sub_f32 v51, 1.0, v49
    v_cvt_pk_bf16_f32 v51, v51, v51
    v_and_b32 v51, 0xffff0000, v51
    v_lshlrev_b32 v36, 16, v28
    v_and_b32 v37, 0xffff0000, v28
    v_lshlrev_b32 v38, 16, v29
    v_and_b32 v39, 0xffff0000, v29
    v_lshlrev_b32 v40, 16, v30
    v_and_b32 v41, 0xffff0000, v30
    v_lshlrev_b32 v42, 16, v31
    v_and_b32 v43, 0xffff0000, v31
    v_lshlrev_b32 v44, 16, v32
    v_and_b32 v45, 0xffff0000, v32
    v_lshlrev_b32 v46, 16, v33
    v_and_b32 v47, 0xffff0000, v33
    v_lshlrev_b32 v52, 16, v34
    v_and_b32 v53, 0xffff0000, v34
    v_lshlrev_b32 v54, 16, v35
    v_and_b32 v55, 0xffff0000, v35
    s_mov_b32 s20, s6
    s_and_b32 s21, s7, 0xffff
    s_setprio 0
    s_cmp_lg_u32 s26, 1
    s_cbranch_scc1 L_ng_119
L_gp_120:
    buffer_load_dword v171, v174, s[8:11], s35 offen sc1
    s_waitcnt vmcnt(0)
    v_readfirstlane_b32 s32, v171
    s_sub_u32 s46, s46, 1
    s_cbranch_scc1 L_ng_119
    s_cmp_lt_u32 s32, 32
    s_cbranch_scc1 L_gp_120
L_ng_119:
    s_lshr_b32 s32, s25, 6
    s_lshl_b32 s33, s26, 8
    s_or_b32 s33, s33, s30
    s_cmp_lg_u32 s32, s33
    s_cbranch_scc1 L_ny_116
    v_lshlrev_b32 v6, 7, v2
    s_mov_b32 s33, 483328
L_sp2_117:
    buffer_load_dword v171, v6, s[8:11], s33 offen sc1
    s_waitcnt vmcnt(0)
    v_cmp_ne_u32 vcc, 48, v171
    s_sub_u32 s46, s46, 1
    s_cbranch_scc1 L_sg_118
    s_sleep 8
    s_cbranch_vccnz L_sp2_117
L_sg_118:
    s_setprio 2
    v_mul_u32_u24 v6, 2560, v2
    v_lshl_add_u32 v6, v3, 4, v6
    s_lshl_b32 s32, s54, 1
    s_add_u32 s32, s32, 425984
    buffer_load_dwordx4 v[56:59], v6, s[8:11], s32 offen offset:0 sc1
    buffer_load_dwordx4 v[60:63], v6, s[8:11], s32 offen offset:64 sc1
    buffer_load_dwordx4 v[64:67], v6, s[8:11], s32 offen offset:128 sc1
    buffer_load_dwordx4 v[68:71], v6, s[8:11], s32 offen offset:192 sc1
    buffer_load_dwordx4 v[72:75], v6, s[8:11], s32 offen offset:256 sc1
    s_lshl_b32 s32, s25, 2
    s_add_u32 s32, s32, 397312
    v_mov_b32 v6, 0
    buffer_load_dword v171, v6, s[8:11], s32 offen sc1
    s_waitcnt vmcnt(0)
    s_nop 1
    v_add_f32_dpp v56, v56, v56 row_ror:8 row_mask:0xf bank_mask:0xf
    v_add_f32_dpp v57, v57, v57 row_ror:8 row_mask:0xf bank_mask:0xf
    v_add_f32_dpp v58, v58, v58 row_ror:8 row_mask:0xf bank_mask:0xf
    v_add_f32_dpp v59, v59, v59 row_ror:8 row_mask:0xf bank_mask:0xf
    v_add_f32_dpp v60, v60, v60 row_ror:8 row_mask:0xf bank_mask:0xf
    v_add_f32_dpp v61, v61, v61 row_ror:8 row_mask:0xf bank_mask:0xf
    v_add_f32_dpp v62, v62, v62 row_ror:8 row_mask:0xf bank_mask:0xf
    v_add_f32_dpp v63, v63, v63 row_ror:8 row_mask:0xf bank_mask:0xf
    v_add_f32_dpp v64, v64, v64 row_ror:8 row_mask:0xf bank_mask:0xf
    v_add_f32_dpp v65, v65, v65 row_ror:8 row_mask:0xf bank_mask:0xf
    v_add_f32_dpp v66, v66, v66 row_ror:8 row_mask:0xf bank_mask:0xf
    v_add_f32_dpp v67, v67, v67 row_ror:8 row_mask:0xf bank_mask:0xf
    v_add_f32_dpp v68, v68, v68 row_ror:8 row_mask:0xf bank_mask:0xf
    v_add_f32_dpp v69, v69, v69 row_ror:8 row_mask:0xf bank_mask:0xf
    v_add_f32_dpp v70, v70, v70 row_ror:8 row_mask:0xf bank_mask:0xf
    v_add_f32_dpp v71, v71, v71 row_ror:8 row_mask:0xf bank_mask:0xf
    v_add_f32_dpp v72, v72, v72 row_ror:8 row_mask:0xf bank_mask:0xf
    v_add_f32_dpp v73, v73, v73 row_ror:8 row_mask:0xf bank_mask:0xf
    v_add_f32_dpp v74, v74, v74 row_ror:8 row_mask:0xf bank_mask:0xf
    v_add_f32_dpp v75, v75, v75 row_ror:8 row_mask:0xf bank_mask:0xf
    s_nop 1
    v_add_f32_dpp v56, v56, v56 row_ror:4 row_mask:0xf bank_mask:0xf
    v_add_f32_dpp v57, v57, v57 row_ror:4 row_mask:0xf bank_mask:0xf
    v_add_f32_dpp v58, v58, v58 row_ror:4 row_mask:0xf bank_mask:0xf
    v_add_f32_dpp v59, v59, v59 row_ror:4 row_mask:0xf bank_mask:0xf
    v_add_f32_dpp v60, v60, v60 row_ror:4 row_mask:0xf bank_mask:0xf
    v_add_f32_dpp v61, v61, v61 row_ror:4 row_mask:0xf bank_mask:0xf
    v_add_f32_dpp v62, v62, v62 row_ror:4 row_mask:0xf bank_mask:0xf
    v_add_f32_dpp v63, v63, v63 row_ror:4 row_mask:0xf bank_mask:0xf
    v_add_f32_dpp v64, v64, v64 row_ror:4 row_mask:0xf bank_mask:0xf
    v_add_f32_dpp v65, v65, v65 row_ror:4 row_mask:0xf bank_mask:0xf
    v_add_f32_dpp v66, v66, v66 row_ror:4 row_mask:0xf bank_mask:0xf
    v_add_f32_dpp v67, v67, v67 row_ror:4 row_mask:0xf bank_mask:0xf
    v_add_f32_dpp v68, v68, v68 row_ror:4 row_mask:0xf bank_mask:0xf
    v_add_f32_dpp v69, v69, v69 row_ror:4 row_mask:0xf bank_mask:0xf
    v_add_f32_dpp v70, v70, v70 row_ror:4 row_mask:0xf bank_mask:0xf
    v_add_f32_dpp v71, v71, v71 row_ror:4 row_mask:0xf bank_mask:0xf
    v_add_f32_dpp v72, v72, v72 row_ror:4 row_mask:0xf bank_mask:0xf
    v_add_f32_dpp v73, v73, v73 row_ror:4 row_mask:0xf bank_mask:0xf
    v_add_f32_dpp v74, v74, v74 row_ror:4 row_mask:0xf bank_mask:0xf
    v_add_f32_dpp v75, v75, v75 row_ror:4 row_mask:0xf bank_mask:0xf
    s_nop 1
    v_add_f32_dpp v56, v56, v56 row_ror:2 row_mask:0xf bank_mask:0xf
    v_add_f32_dpp v57, v57, v57 row_ror:2 row_mask:0xf bank_mask:0xf
    v_add_f32_dpp v58, v58, v58 row_ror:2 row_mask:0xf bank_mask:0xf
    v_add_f32_dpp v59, v59, v59 row_ror:2 row_mask:0xf bank_mask:0xf
    v_add_f32_dpp v60, v60, v60 row_ror:2 row_mask:0xf bank_mask:0xf
    v_add_f32_dpp v61, v61, v61 row_ror:2 row_mask:0xf bank_mask:0xf
    v_add_f32_dpp v62, v62, v62 row_ror:2 row_mask:0xf bank_mask:0xf
    v_add_f32_dpp v63, v63, v63 row_ror:2 row_mask:0xf bank_mask:0xf
    v_add_f32_dpp v64, v64, v64 row_ror:2 row_mask:0xf bank_mask:0xf
    v_add_f32_dpp v65, v65, v65 row_ror:2 row_mask:0xf bank_mask:0xf
    v_add_f32_dpp v66, v66, v66 row_ror:2 row_mask:0xf bank_mask:0xf
    v_add_f32_dpp v67, v67, v67 row_ror:2 row_mask:0xf bank_mask:0xf
    v_add_f32_dpp v68, v68, v68 row_ror:2 row_mask:0xf bank_mask:0xf
    v_add_f32_dpp v69, v69, v69 row_ror:2 row_mask:0xf bank_mask:0xf
    v_add_f32_dpp v70, v70, v70 row_ror:2 row_mask:0xf bank_mask:0xf
    v_add_f32_dpp v71, v71, v71 row_ror:2 row_mask:0xf bank_mask:0xf
    v_add_f32_dpp v72, v72, v72 row_ror:2 row_mask:0xf bank_mask:0xf
    v_add_f32_dpp v73, v73, v73 row_ror:2 row_mask:0xf bank_mask:0xf
    v_add_f32_dpp v74, v74, v74 row_ror:2 row_mask:0xf bank_mask:0xf
    v_add_f32_dpp v75, v75, v75 row_ror:2 row_mask:0xf bank_mask:0xf
    s_nop 1
    v_add_f32_dpp v56, v56, v56 row_ror:1 row_mask:0xf bank_mask:0xf
    v_add_f32_dpp v57, v57, v57 row_ror:1 row_mask:0xf bank_mask:0xf
    v_add_f32_dpp v58, v58, v58 row_ror:1 row_mask:0xf bank_mask:0xf
    v_add_f32_dpp v59, v59, v59 row_ror:1 row_mask:0xf bank_mask:0xf
    v_add_f32_dpp v60, v60, v60 row_ror:1 row_mask:0xf bank_mask:0xf
    v_add_f32_dpp v61, v61, v61 row_ror:1 row_mask:0xf bank_mask:0xf
    v_add_f32_dpp v62, v62, v62 row_ror:1 row_mask:0xf bank_mask:0xf
    v_add_f32_dpp v63, v63, v63 row_ror:1 row_mask:0xf bank_mask:0xf
    v_add_f32_dpp v64, v64, v64 row_ror:1 row_mask:0xf bank_mask:0xf
    v_add_f32_dpp v65, v65, v65 row_ror:1 row_mask:0xf bank_mask:0xf
    v_add_f32_dpp v66, v66, v66 row_ror:1 row_mask:0xf bank_mask:0xf
    v_add_f32_dpp v67, v67, v67 row_ror:1 row_mask:0xf bank_mask:0xf
    v_add_f32_dpp v68, v68, v68 row_ror:1 row_mask:0xf bank_mask:0xf
    v_add_f32_dpp v69, v69, v69 row_ror:1 row_mask:0xf bank_mask:0xf
    v_add_f32_dpp v70, v70, v70 row_ror:1 row_mask:0xf bank_mask:0xf
    v_add_f32_dpp v71, v71, v71 row_ror:1 row_mask:0xf bank_mask:0xf
    v_add_f32_dpp v72, v72, v72 row_ror:1 row_mask:0xf bank_mask:0xf
    v_add_f32_dpp v73, v73, v73 row_ror:1 row_mask:0xf bank_mask:0xf
    v_add_f32_dpp v74, v74, v74 row_ror:1 row_mask:0xf bank_mask:0xf
    v_add_f32_dpp v75, v75, v75 row_ror:1 row_mask:0xf bank_mask:0xf
    v_cvt_pk_bf16_f32 v171, v171, v171
    v_and_b32 v171, 0xffff0000, v171
    v_mul_f32 v6, 0xbfb8aa3b, v171
    v_exp_f32 v6, v6
    s_nop 0
    v_add_f32 v6, 1.0, v6
    v_rcp_f32 v171, v6
    s_nop 0
    v_cvt_pk_bf16_f32 v171, v171, v171
    v_and_b32 v171, 0xffff0000, v171
    v_cvt_pk_bf16_f32 v56, v56, v56
    v_and_b32 v56, 0xffff0000, v56
    v_mul_f32 v56, v56, v171
    v_cvt_pk_bf16_f32 v56, v56, v56
    v_and_b32 v56, 0xffff0000, v56
    v_cvt_pk_bf16_f32 v57, v57, v57
    v_and_b32 v57, 0xffff0000, v57
    v_mul_f32 v57, v57, v171
    v_cvt_pk_bf16_f32 v57, v57, v57
    v_and_b32 v57, 0xffff0000, v57
    v_cvt_pk_bf16_f32 v58, v58, v58
    v_and_b32 v58, 0xffff0000, v58
    v_mul_f32 v58, v58, v171
    v_cvt_pk_bf16_f32 v58, v58, v58
    v_and_b32 v58, 0xffff0000, v58
    v_cvt_pk_bf16_f32 v59, v59, v59
    v_and_b32 v59, 0xffff0000, v59
    v_mul_f32 v59, v59, v171
    v_cvt_pk_bf16_f32 v59, v59, v59
    v_and_b32 v59, 0xffff0000, v59
    v_cvt_pk_bf16_f32 v60, v60, v60
    v_and_b32 v60, 0xffff0000, v60
    v_mul_f32 v60, v60, v171
    v_cvt_pk_bf16_f32 v60, v60, v60
    v_and_b32 v60, 0xffff0000, v60
    v_cvt_pk_bf16_f32 v61, v61, v61
    v_and_b32 v61, 0xffff0000, v61
    v_mul_f32 v61, v61, v171
    v_cvt_pk_bf16_f32 v61, v61, v61
    v_and_b32 v61, 0xffff0000, v61
    v_cvt_pk_bf16_f32 v62, v62, v62
    v_and_b32 v62, 0xffff0000, v62
    v_mul_f32 v62, v62, v171
    v_cvt_pk_bf16_f32 v62, v62, v62
    v_and_b32 v62, 0xffff0000, v62
    v_cvt_pk_bf16_f32 v63, v63, v63
    v_and_b32 v63, 0xffff0000, v63
    v_mul_f32 v63, v63, v171
    v_cvt_pk_bf16_f32 v63, v63, v63
    v_and_b32 v63, 0xffff0000, v63
    v_cvt_pk_bf16_f32 v64, v64, v64
    v_and_b32 v64, 0xffff0000, v64
    v_mul_f32 v64, v64, v171
    v_cvt_pk_bf16_f32 v64, v64, v64
    v_and_b32 v64, 0xffff0000, v64
    v_cvt_pk_bf16_f32 v65, v65, v65
    v_and_b32 v65, 0xffff0000, v65
    v_mul_f32 v65, v65, v171
    v_cvt_pk_bf16_f32 v65, v65, v65
    v_and_b32 v65, 0xffff0000, v65
    v_cvt_pk_bf16_f32 v66, v66, v66
    v_and_b32 v66, 0xffff0000, v66
    v_mul_f32 v66, v66, v171
    v_cvt_pk_bf16_f32 v66, v66, v66
    v_and_b32 v66, 0xffff0000, v66
    v_cvt_pk_bf16_f32 v67, v67, v67
    v_and_b32 v67, 0xffff0000, v67
    v_mul_f32 v67, v67, v171
    v_cvt_pk_bf16_f32 v67, v67, v67
    v_and_b32 v67, 0xffff0000, v67
    v_cvt_pk_bf16_f32 v68, v68, v68
    v_and_b32 v68, 0xffff0000, v68
    v_mul_f32 v68, v68, v171
    v_cvt_pk_bf16_f32 v68, v68, v68
    v_and_b32 v68, 0xffff0000, v68
    v_cvt_pk_bf16_f32 v69, v69, v69
    v_and_b32 v69, 0xffff0000, v69
    v_mul_f32 v69, v69, v171
    v_cvt_pk_bf16_f32 v69, v69, v69
    v_and_b32 v69, 0xffff0000, v69
    v_cvt_pk_bf16_f32 v70, v70, v70
    v_and_b32 v70, 0xffff0000, v70
    v_mul_f32 v70, v70, v171
    v_cvt_pk_bf16_f32 v70, v70, v70
    v_and_b32 v70, 0xffff0000, v70
    v_cvt_pk_bf16_f32 v71, v71, v71
    v_and_b32 v71, 0xffff0000, v71
    v_mul_f32 v71, v71, v171
    v_cvt_pk_bf16_f32 v71, v71, v71
    v_and_b32 v71, 0xffff0000, v71
    v_cvt_pk_bf16_f32 v72, v72, v72
    v_and_b32 v72, 0xffff0000, v72
    v_mul_f32 v72, v72, v171
    v_cvt_pk_bf16_f32 v72, v72, v72
    v_and_b32 v72, 0xffff0000, v72
    v_cvt_pk_bf16_f32 v73, v73, v73
    v_and_b32 v73, 0xffff0000, v73
    v_mul_f32 v73, v73, v171
    v_cvt_pk_bf16_f32 v73, v73, v73
    v_and_b32 v73, 0xffff0000, v73
    v_cvt_pk_bf16_f32 v74, v74, v74
    v_and_b32 v74, 0xffff0000, v74
    v_mul_f32 v74, v74, v171
    v_cvt_pk_bf16_f32 v74, v74, v74
    v_and_b32 v74, 0xffff0000, v74
    v_cvt_pk_bf16_f32 v75, v75, v75
    v_and_b32 v75, 0xffff0000, v75
    v_mul_f32 v75, v75, v171
    v_cvt_pk_bf16_f32 v75, v75, v75
    v_and_b32 v75, 0xffff0000, v75
    v_lshlrev_b32 v6, 4, v3
    v_add_u32 v6, 163456, v6
    s_mov_b32 s32, 0x00010001
    s_mov_b32 s33, 0x00010001
    s_mov_b64 exec, s[32:33]
    ds_write_b128 v6, v[56:59] offset:0
    ds_write_b128 v6, v[60:63] offset:64
    ds_write_b128 v6, v[64:67] offset:128
    ds_write_b128 v6, v[68:71] offset:192
    ds_write_b128 v6, v[72:75] offset:256
    s_mov_b64 exec, -1
    s_setprio 0
L_ny_116:
    s_mov_b32 s46, 100000
    s_waitcnt vmcnt(0) lgkmcnt(0)
    s_barrier
    s_setprio 2
    s_branch L_h3_55
L_CODE_END:
.section .rodata,"a"
.p2align 6
.amdhsa_kernel gated_mix__grouped_kv_mqa__moe_arch_mod__prompt_kernel
  .amdhsa_next_free_vgpr 256
  .amdhsa_next_free_sgpr 102
  .amdhsa_accum_offset 256
  .amdhsa_group_segment_fixed_size 0
  .amdhsa_kernarg_size 112
  .amdhsa_user_sgpr_count 2
  .amdhsa_user_sgpr_kernarg_segment_ptr 1
  .amdhsa_system_sgpr_workgroup_id_x 1
.end_amdhsa_kernel
```
